```python
import torch

def _softmax(x, axis=-1):
    return torch.softmax(x, dim=axis)
def _gelu(x):
    return torch.nn.functional.gelu(x, approximate="tanh")
def _silu(x):
    return torch.nn.functional.silu(x)
def _sigmoid(x):
    return torch.sigmoid(x)
def _layernorm(x, axis=-1, eps=1e-5):
    m = x.mean(dim=axis, keepdim=True)
    v = x.var(dim=axis, keepdim=True, unbiased=False)
    return (x - m) / torch.sqrt(v + eps)
def _scatter_add(tgt, idx, src, axis=0):
    return tgt.clone().index_add_(axis, idx, src)
def _segment_sum(src, seg, n):
    out = torch.zeros((n,) + src.shape[1:], dtype=src.dtype)
    return out.index_add_(0, seg, src)
def _pad(x, pw):
    flat = tuple(v for pair in reversed(pw) for v in pair)
    return torch.nn.functional.pad(x, flat)

kernel_name = 'parallel_sum__ssm_conv_s4__dense_activation_relu__prompt'

def setup_inputs():

    _w = (lambda a: (lambda t: t.to(torch.bfloat16) if t.is_floating_point() else t)(torch.as_tensor(a)))
    def _A_setup():
        B, L, D, N = 1, 2048, 512, 128
        A_re = -(lambda _x: torch.exp(torch.as_tensor(_x)))((lambda *s: torch.randn(*s, dtype=torch.bfloat16) * 3.2)(D, N))
        A_im = torch.pi * (lambda *s: torch.randn(*s, dtype=torch.bfloat16) * 0.2)(D, N)
        B_re = (lambda *s: torch.randn(*s, dtype=torch.bfloat16) * 0.4)(D, N)
        B_im = (lambda *s: torch.randn(*s, dtype=torch.bfloat16) * 0.4)(D, N)
        C_re = (lambda *s: torch.randn(*s, dtype=torch.bfloat16) * 0.4)(D, N)
        C_im = (lambda *s: torch.randn(*s, dtype=torch.bfloat16) * 0.4)(D, N)
        log_dt = (lambda *s: torch.randn(*s, dtype=torch.bfloat16) * 0.2)(D) * 0.5 - 4.0
        Dskip = (lambda *s: torch.randn(*s, dtype=torch.bfloat16) * 0.4)(D)
        return {
            "u": _w((lambda *s: torch.randn(*s, dtype=torch.bfloat16) * 0.05)(B, L, D)),
            "A_re": _w(A_re),
            "A_im": _w(A_im),
            "B_re": _w(B_re),
            "B_im": _w(B_im),
            "C_re": _w(C_re),
            "C_im": _w(C_im),
            "log_dt": _w(log_dt),
            "Dskip": _w(Dskip),
        }
    _A_in = _A_setup()

    def _B_setup():
        B, S, D, Dff = 1, 2048, 512, 1792
        return {
            "x": _w((lambda *s: torch.randn(*s, dtype=torch.bfloat16) * 0.05)(B, S, D)),
            "w1": _w((lambda *s: torch.randn(*s, dtype=torch.bfloat16) * 0.05)(D, Dff)),
            "w2": _w((lambda *s: torch.randn(*s, dtype=torch.bfloat16) * 0.05)(Dff, D)),
        }
    _B_in = _B_setup()

    return {
        "A_u": _A_in["u"],
        "A_A_re": _A_in["A_re"],
        "A_A_im": _A_in["A_im"],
        "A_B_re": _A_in["B_re"],
        "A_B_im": _A_in["B_im"],
        "A_C_re": _A_in["C_re"],
        "A_C_im": _A_in["C_im"],
        "A_log_dt": _A_in["log_dt"],
        "A_Dskip": _A_in["Dskip"],
        "B_x": _B_in["x"],
        "B_w1": _B_in["w1"],
        "B_w2": _B_in["w2"],
    }

def reference(A_u, A_A_re, A_A_im, A_B_re, A_B_im, A_C_re, A_C_im, A_log_dt, A_Dskip, B_x, B_w1, B_w2):
    def _A_ref(u, A_re, A_im, B_re, B_im, C_re, C_im, log_dt, Dskip):
        Bsz, L, D = u.shape
        dt = torch.exp(log_dt)[:, None]
        A = A_re + 1j * A_im
        Bc = B_re + 1j * B_im
        Cc = C_re + 1j * C_im
        logdA = dt * A
        dB = dt * Bc
        l = (lambda x, dt: x.to(dt))(torch.arange(L), A_re.dtype)
        P = torch.exp(logdA[:, :, None] * l[None, None, :])
        K = torch.einsum("dn,dnl,dn->dl", Cc, P, dB).real
        L2 = 2 * L
        Kp = _pad(K, ((0, 0), (0, L)))
        up = (lambda x, *d: x.permute(*d))(u, 0, 2, 1)
        up = _pad(up, ((0, 0), (0, 0), (0, L)))
        Kf = (lambda x, axes=(-2,-1): torch.fft.rfft2(x.float(), dim=axes))(Kp[:, None, :], axes=(-2, -1))
        Uf = (lambda x, axes=(-2,-1): torch.fft.rfft2(x.float(), dim=axes))(up[:, :, None, :], axes=(-2, -1))
        Yf = Uf * Kf[None, :, :, :]
        y = (lambda x, s, axes=(-2,-1): torch.fft.irfft2(x, s=s, dim=axes).to(torch.bfloat16))(Yf, (1, L2), axes=(-2, -1))[:, :, 0, :L]
        y = (lambda x, *d: x.permute(*d))(y, 0, 2, 1) + u * Dskip[None, None, :]
        return y

    def _B_ref(x, w1, w2):
        h = torch.einsum("bsd,df->bsf", x, w1)
        zero = torch.zeros_like(h)
        h = torch.maximum(h, zero)
        return torch.einsum("bsf,fd->bsd", h, w2)

    x = A_u
    xn = _layernorm(x, axis=-1)
    return x + _A_ref(xn, A_A_re, A_A_im, A_B_re, A_B_im, A_C_re, A_C_im, A_log_dt, A_Dskip) + _B_ref(xn, B_w1, B_w2)
```

```asm
; @launch grid=(256,1,1) block=(512,1,1) lds=163840
.amdgcn_target "amdgcn-amd-amdhsa--gfx950"
.text
.globl parallel_sum__ssm_conv_s4__dense_activation_relu__prompt_kernel
.p2align 8
.type parallel_sum__ssm_conv_s4__dense_activation_relu__prompt_kernel,@function
parallel_sum__ssm_conv_s4__dense_activation_relu__prompt_kernel:
    s_cmp_ge_u32 s2, 256
    s_cbranch_scc1 L_end
    s_load_dwordx16 s[44:59], s[0:1], 0
    s_load_dwordx2 s[60:61], s[0:1], 64
    s_load_dwordx4 s[64:67], s[0:1], 80
    s_load_dwordx4 s[68:71], s[0:1], 96
    s_load_dwordx2 s[72:73], s[0:1], 112
    v_lshrrev_b32 v1, 6, v0
    v_and_b32 v0, 63, v0
    v_readfirstlane_b32 s32, v1
    s_and_b32 s34, s2, 7
    s_lshr_b32 s35, s2, 3
    s_getpc_b64 s[62:63]
L_pc:
    s_lshl3_add_u32 s4, s35, s32
    s_lshl_b32 s4, s4, 7
    s_min_u32 s4, s4, L_end-L_pc
    v_mov_b32 v5, s4
    s_mov_b64 exec, 1
    global_load_dword v125, v5, s[62:63]
    s_mov_b64 exec, -1
    s_lshl_b32 s38, s34, 5
    s_add_u32 s38, s38, s35
    s_and_b32 s33, s32, 3
    s_lshr_b32 s84, s33, 1
    s_and_b32 s86, s33, 1
    s_lshr_b32 s3, s38, 1
    s_lshl1_add_u32 s85, s3, s84
    s_and_b32 s4, s38, 1
    s_lshl1_add_u32 s85, s85, s4
    s_cmp_lt_u32 s32, 4
    s_cbranch_scc1 L_M0
    s_lshl_b32 s4, s85, 8
    s_lshl_b32 s5, s86, 7
    s_add_u32 s4, s4, s5
    v_lshl_add_u32 v6, v0, 1, s4
    s_lshr_b32 s4, s85, 1
    s_lshl_b32 s4, s4, 2
    s_waitcnt lgkmcnt(0)
    global_load_short_d16_hi v24, v6, s[46:47]
    global_load_short_d16_hi v25, v6, s[48:49]
    global_load_short_d16_hi v26, v6, s[50:51]
    global_load_short_d16_hi v27, v6, s[52:53]
    global_load_short_d16_hi v28, v6, s[54:55]
    global_load_short_d16_hi v29, v6, s[56:57]
    s_load_dword s87, s[58:59], s4
    s_load_dword s88, s[60:61], s4
    s_mov_b32 s28, s70
    s_and_b32 s29, s71, 0xffff
    s_mov_b32 s30, 256
    s_mov_b32 s31, 0x20000
    s_mov_b32 s8, s44
    s_and_b32 s9, s45, 0xffff
    s_mov_b32 s10, 2097152
    s_mov_b32 s11, 0x20000
    s_mov_b32 s20, s72
    s_and_b32 s21, s73, 0xffff
    s_mov_b32 s22, 2097152
    s_mov_b32 s23, 0x20000
    s_cmp_lg_u32 s2, 0
    s_cbranch_scc1 L_common
    s_cmp_lg_u32 s32, 4
    s_cbranch_scc1 L_common
    s_memrealtime s[90:91]
    s_waitcnt lgkmcnt(0)
    s_or_b32 s90, s90, 1
    v_mov_b32 v8, s90
    v_mov_b32 v9, 0
    s_mov_b64 exec, 1
    buffer_store_dword v8, v9, s[28:31], 0 offen sc1
    s_mov_b64 exec, -1
    s_branch L_common
L_M0:
    s_lshl_b32 s4, s38, 13
    s_lshl_b32 s5, s33, 8
    s_add_u32 s4, s4, s5
    v_lshl_add_u32 v6, v0, 2, s4
    s_movk_i32 s4, 0x1000
    s_waitcnt lgkmcnt(0)
    s_mov_b32 s8, s44
    s_and_b32 s9, s45, 0xffff
    s_mov_b32 s10, 2097152
    s_mov_b32 s11, 0x20000
    buffer_load_dword v16, v6, s[8:11], 0 offen offset:0
    buffer_load_dword v17, v6, s[8:11], 0 offen offset:1024
    buffer_load_dword v18, v6, s[8:11], 0 offen offset:2048
    buffer_load_dword v19, v6, s[8:11], 0 offen offset:3072
    buffer_load_dword v20, v6, s[8:11], s4 offen offset:0
    buffer_load_dword v21, v6, s[8:11], s4 offen offset:1024
    buffer_load_dword v22, v6, s[8:11], s4 offen offset:2048
    buffer_load_dword v23, v6, s[8:11], s4 offen offset:3072
    s_mov_b32 s28, s70
    s_and_b32 s29, s71, 0xffff
    s_mov_b32 s30, 256
    s_mov_b32 s31, 0x20000
    s_mov_b32 s20, s66
    s_and_b32 s21, s67, 0xffff
    s_mov_b32 s22, 1835008
    s_mov_b32 s23, 0x20000
L_common:
    s_lshr_b32 s36, s34, 1
    s_lshl_b32 s36, s36, 2
    s_and_b32 s3, s35, 3
    s_add_u32 s36, s36, s3
    s_and_b32 s37, s34, 1
    s_lshl_b32 s37, s37, 3
    s_lshr_b32 s40, s35, 2
    s_add_u32 s37, s37, s40
    s_and_b32 s42, s37, 1
    s_lshl_b32 s7, s33, 12
    s_lshl_b32 s43, s40, 1
    s_lshl_b32 s4, s3, 2
    s_add_u32 s43, s43, s4
    s_and_b32 s43, s43, 15
    v_lshrrev_b32 v1, 2, v0
    v_and_b32 v2, 3, v0
    v_lshrrev_b32 v5, 5, v0
    v_lshlrev_b32 v5, 1, v5
    v_xor_b32 v2, v2, v5
    v_lshlrev_b32 v2, 4, v2
    s_sub_u32 s12, s64, 2048
    s_subb_u32 s13, s65, 0
    s_and_b32 s13, s13, 0xffff
    s_mov_b32 s14, 1837056
    s_mov_b32 s15, 0x20000
    s_lshl_b32 s4, s36, 7
    s_lshl_b32 s5, s33, 5
    s_add_u32 s4, s4, s5
    s_lshl_b32 s4, s4, 10
    v_lshlrev_b32 v5, 10, v1
    v_add3_u32 v5, v5, v2, s4
    s_mul_i32 s4, s37, 224
    s_lshl_b32 s5, s42, 5
    s_sub_u32 s4, s4, s5
    s_lshl_b32 s5, s33, 6
    s_add_u32 s4, s4, s5
    v_mul_u32_u24 v7, 3584, v1
    v_add3_u32 v7, v7, v2, s4
    s_barrier
    v_and_b32 v3, 15, v0
    v_lshrrev_b32 v4, 4, v0
    v_lshlrev_b32 v15, 4, v0
    s_mov_b32 s16, s72
    s_and_b32 s17, s73, 0xffff
    s_mov_b32 s18, 17825792
    s_mov_b32 s19, 0x20000
    s_mov_b32 s24, s68
    s_and_b32 s25, s69, 0xffff
    s_mov_b32 s26, 2097152
    s_mov_b32 s27, 0x20000
    s_lshl_b32 s39, s34, 2
    s_add_u32 s39, s39, s3
    s_cmp_lt_u32 s32, 4
    s_cbranch_scc0 L_Xr
L_M:
    s_add_u32 s97, s43, 0
    s_and_b32 s97, s97, 15
    s_lshl_b32 s4, s97, 6
    s_add_u32 m0, s7, 0
    s_add_u32 s5, s4, 15360
    buffer_load_dwordx4 v5, s[8:11], s4 offen lds
    buffer_load_dwordx4 v5, s[8:11], s5 offen offset:1024 lds
    s_add_u32 m0, s7, 16384
    s_add_u32 s4, s4, 64
    s_add_u32 s5, s5, 64
    buffer_load_dwordx4 v5, s[8:11], s4 offen lds
    buffer_load_dwordx4 v5, s[8:11], s5 offen offset:1024 lds
    s_add_u32 s97, s43, 0
    s_and_b32 s97, s97, 15
    s_mul_i32 s4, s97, 114688
    s_add_u32 m0, s7, 0
    s_add_u32 s5, s4, 56320
    buffer_load_dwordx4 v7, s[12:15], s4 offen offset:2048 lds
    buffer_load_dwordx4 v7, s[12:15], s5 offen offset:3072 lds
    v_lshrrev_b32 v8, 3, v0
    v_bfe_u32 v9, v0, 4, 1
    v_and_b32 v13, 7, v0
    v_xor_b32 v9, v9, v13
    v_lshlrev_b32 v9, 4, v9
    v_lshl_add_u32 v8, v8, 10, v9
    s_lshl_b32 s79, s33, 8
    s_add_u32 s79, s79, s2
    s_lshr_b32 s4, s79, 3
    s_lshl_b32 s4, s4, 15
    s_and_b32 s5, s79, 7
    s_lshl_b32 s5, s5, 7
    s_add_u32 s4, s4, s5
    s_add_u32 s80, s7, 132608
    s_mov_b32 m0, s80
    s_nop 0
    buffer_load_dwordx4 v8, s[20:23], s4 offen offset:0 lds
    s_add_u32 s4, s4, 7168
    buffer_load_dwordx4 v8, s[20:23], s4 offen offset:1024 lds
    s_add_u32 s4, s4, 7168
    buffer_load_dwordx4 v8, s[20:23], s4 offen offset:2048 lds
    s_add_u32 s4, s4, 7168
    buffer_load_dwordx4 v8, s[20:23], s4 offen offset:3072 lds
    v_lshrrev_b32 v10, 2, v3
    v_lshl_add_u32 v10, v4, 3, v10
    v_lshlrev_b32 v10, 6, v10
    v_and_b32 v11, 3, v3
    v_lshl_add_u32 v10, v11, 3, v10
    v_add_u32 v10, 2048, v10
    v_and_b32 v11, 1, v4
    v_lshlrev_b32 v11, 5, v11
    v_xor_b32 v12, 32, v11
    v_add_u32 v1, v10, v11
    v_add_u32 v2, v10, v12
    s_mul_i32 s4, s37, 7
    s_sub_u32 s4, s4, s42
    s_lshr_b32 s4, s4, 1
    s_lshl_b32 s5, s36, 3
    s_lshl1_add_u32 s5, s33, s5
    s_mul_i32 s5, s5, 56
    s_add_u32 s4, s4, s5
    s_lshl_b32 s4, s4, 10
    s_add_u32 s6, s4, 4194304
    v_lshlrev_b32 v14, 4, v4
    v_add_u32 v14, 155232, v14
    s_cmp_eq_u32 s42, 1
    s_cselect_b32 s4, 0, 12288
    s_cselect_b64 vcc, -1, 0
    v_cndmask_b32 v118, v1, v2, vcc
    v_add_u32 v118, s4, v118
    s_cmp_eq_u32 s33, 3
    s_cselect_b32 s3, 0, s33
    s_add_u32 s5, s3, 0
    s_sub_u32 s4, s5, 3
    s_cmp_ge_u32 s5, 3
    s_cselect_b32 s5, s4, s5
    s_lshl_b32 s4, s5, 7
    v_add_u32 v10, s4, v14
    s_add_u32 s5, s5, s42
    s_lshl_b32 s4, s5, 12
    v_add_u32 v112, s4, v1
    v_add_u32 v113, s4, v2
    s_lshl_b32 s4, s5, 10
    s_add_u32 s74, s4, s6
    s_add_u32 s70, s74, 57344
    s_add_u32 s5, s3, 1
    s_sub_u32 s4, s5, 3
    s_cmp_ge_u32 s5, 3
    s_cselect_b32 s5, s4, s5
    s_lshl_b32 s4, s5, 7
    v_add_u32 v11, s4, v14
    s_add_u32 s5, s5, s42
    s_lshl_b32 s4, s5, 12
    v_add_u32 v114, s4, v1
    v_add_u32 v115, s4, v2
    s_lshl_b32 s4, s5, 10
    s_add_u32 s75, s4, s6
    s_add_u32 s71, s75, 57344
    s_add_u32 s5, s3, 2
    s_sub_u32 s4, s5, 3
    s_cmp_ge_u32 s5, 3
    s_cselect_b32 s5, s4, s5
    s_lshl_b32 s4, s5, 7
    v_add_u32 v12, s4, v14
    s_add_u32 s5, s5, s42
    s_lshl_b32 s4, s5, 12
    v_add_u32 v116, s4, v1
    v_add_u32 v117, s4, v2
    s_lshl_b32 s4, s5, 10
    s_add_u32 s76, s4, s6
    s_add_u32 s72, s76, 57344
    s_lshl2_add_u32 s4, s36, s33
    s_lshl4_add_u32 s4, s4, s37
    s_lshl_b32 s4, s4, 10
    s_add_u32 s77, s4, 16777216
    s_lshl_b32 s4, s3, 7
    v_lshlrev_b32 v13, 5, v4
    v_add_u32 v13, s4, v13
    v_and_b32 v126, 1, v4
    v_cmp_eq_u32 vcc, 1, v126
    v_mov_b32 v126, 384
    s_nop 0
    v_cndmask_b32 v13, v13, v126, vcc
    v_and_b32 v126, 12, v3
    v_lshl_add_u32 v13, v126, 2, v13
    v_add_u32 v13, 155232, v13
    v_lshrrev_b32 v9, 3, v3
    v_lshlrev_b32 v9, 1, v9
    v_xor_b32 v9, v9, v4
    v_lshlrev_b32 v9, 4, v9
    v_lshl_add_u32 v9, v3, 6, v9
    v_add_u32 v9, s7, v9
    v_mov_b32 v120, 0x3f803f80
    v_mov_b32 v121, 0x3f803f80
    s_mul_i32 s4, s33, 14
    s_lshl3_add_u32 s4, s4, s40
    s_lshl_b32 s4, s4, 12
    s_add_u32 s78, s4, 14680064
    s_lshl2_add_u32 s4, s36, s33
    s_lshl4_add_u32 s4, s4, s37
    s_lshl_b32 s4, s4, 5
    s_add_u32 s93, s4, 12713984
    s_and_b32 s4, s38, 63
    s_lshl_b32 s4, s4, 5
    s_lshr_b32 s5, s38, 6
    s_add_u32 s4, s4, s5
    s_lshl_b32 s4, s4, 2
    s_add_u32 s4, s4, 12648448
    s_cmp_eq_u32 s33, 0
    s_cselect_b32 s94, s4, 17825792
    s_lshl_b32 s4, s36, 7
    s_lshl_b32 s5, s33, 5
    s_add_u32 s4, s4, s5
    s_lshl_b32 s4, s4, 3
    s_add_u32 s95, s4, 12582912
    v_lshlrev_b32 v8, 3, v3
    s_lshl_b32 s4, s79, 12
    s_add_u32 s4, s4, 14680064
    s_cmp_lt_u32 s79, 448
    s_cselect_b32 s79, s4, 17825792
    v_lshrrev_b32 v80, 2, v3
    v_lshl_add_u32 v81, v4, 2, v80
    v_lshlrev_b32 v81, 7, v81
    v_lshrrev_b32 v80, 1, v80
    v_and_b32 v126, 3, v3
    v_lshl_or_b32 v80, v126, 1, v80
    v_xor_b32 v126, 1, v80
    v_lshl_add_u32 v80, v80, 4, v81
    v_lshl_add_u32 v81, v126, 4, v81
    v_add_u32 v80, s80, v80
    v_add_u32 v81, s80, v81
    s_lshl_b32 s4, s33, 6
    s_add_u32 s4, s4, 154976
    v_lshl_add_u32 v82, v4, 4, s4
    v_and_b32 v83, 7, v0
    v_lshlrev_b32 v83, 2, v83
    v_add_u32 v83, 154976, v83
    s_lshl_b32 s4, s38, 13
    s_lshl_b32 s5, s33, 10
    s_add_u32 s80, s4, s5
    s_lshl_b32 s4, s38, 6
    s_add_u32 s4, s4, 12582912
    s_cmp_eq_u32 s33, 0
    s_cselect_b32 s89, s4, 17825792
    v_lshlrev_b32 v84, 3, v0
    s_waitcnt vmcnt(10)
    v_lshlrev_b32 v32, 16, v16
    v_and_b32 v40, 0xffff0000, v16
    v_lshlrev_b32 v33, 16, v17
    v_and_b32 v41, 0xffff0000, v17
    v_lshlrev_b32 v34, 16, v18
    v_and_b32 v42, 0xffff0000, v18
    v_lshlrev_b32 v35, 16, v19
    v_and_b32 v43, 0xffff0000, v19
    v_lshlrev_b32 v36, 16, v20
    v_and_b32 v44, 0xffff0000, v20
    v_lshlrev_b32 v37, 16, v21
    v_and_b32 v45, 0xffff0000, v21
    v_lshlrev_b32 v38, 16, v22
    v_and_b32 v46, 0xffff0000, v22
    v_lshlrev_b32 v39, 16, v23
    v_and_b32 v47, 0xffff0000, v23
    v_pk_add_f32 v[48:49], v[32:33], v[40:41]
    v_pk_mul_f32 v[56:57], v[32:33], v[32:33]
    v_pk_add_f32 v[50:51], v[34:35], v[42:43]
    v_pk_mul_f32 v[58:59], v[34:35], v[34:35]
    v_pk_add_f32 v[52:53], v[36:37], v[44:45]
    v_pk_mul_f32 v[60:61], v[36:37], v[36:37]
    v_pk_add_f32 v[54:55], v[38:39], v[46:47]
    v_pk_mul_f32 v[62:63], v[38:39], v[38:39]
    v_pk_fma_f32 v[56:57], v[40:41], v[40:41], v[56:57]
    v_pk_fma_f32 v[58:59], v[42:43], v[42:43], v[58:59]
    v_pk_fma_f32 v[60:61], v[44:45], v[44:45], v[60:61]
    v_pk_fma_f32 v[62:63], v[46:47], v[46:47], v[62:63]
    v_permlane32_swap_b32 v48, v56
    v_permlane32_swap_b32 v49, v57
    v_permlane32_swap_b32 v50, v58
    v_permlane32_swap_b32 v51, v59
    v_permlane32_swap_b32 v52, v60
    v_permlane32_swap_b32 v53, v61
    v_permlane32_swap_b32 v54, v62
    v_permlane32_swap_b32 v55, v63
    v_pk_add_f32 v[48:49], v[48:49], v[56:57]
    v_pk_add_f32 v[50:51], v[50:51], v[58:59]
    v_pk_add_f32 v[52:53], v[52:53], v[60:61]
    v_pk_add_f32 v[54:55], v[54:55], v[62:63]
    s_nop 0
    v_permlane16_swap_b32 v48, v52
    v_permlane16_swap_b32 v49, v53
    v_permlane16_swap_b32 v50, v54
    v_permlane16_swap_b32 v51, v55
    v_pk_add_f32 v[48:49], v[48:49], v[52:53]
    v_pk_add_f32 v[50:51], v[50:51], v[54:55]
    s_nop 0
    v_add_f32_dpp v48, v48, v48 row_ror:8 row_mask:0xf bank_mask:0xf
    v_add_f32_dpp v49, v49, v49 row_ror:8 row_mask:0xf bank_mask:0xf
    v_add_f32_dpp v50, v50, v50 row_ror:8 row_mask:0xf bank_mask:0xf
    v_add_f32_dpp v51, v51, v51 row_ror:8 row_mask:0xf bank_mask:0xf
    v_add_f32_dpp v48, v48, v48 row_ror:4 row_mask:0xf bank_mask:0xf
    v_add_f32_dpp v49, v49, v49 row_ror:4 row_mask:0xf bank_mask:0xf
    v_add_f32_dpp v50, v50, v50 row_ror:4 row_mask:0xf bank_mask:0xf
    v_add_f32_dpp v51, v51, v51 row_ror:4 row_mask:0xf bank_mask:0xf
    v_add_f32_dpp v48, v48, v48 row_ror:2 row_mask:0xf bank_mask:0xf
    v_add_f32_dpp v49, v49, v49 row_ror:2 row_mask:0xf bank_mask:0xf
    v_add_f32_dpp v50, v50, v50 row_ror:2 row_mask:0xf bank_mask:0xf
    v_add_f32_dpp v51, v51, v51 row_ror:2 row_mask:0xf bank_mask:0xf
    v_add_f32_dpp v48, v48, v48 row_ror:1 row_mask:0xf bank_mask:0xf
    v_add_f32_dpp v49, v49, v49 row_ror:1 row_mask:0xf bank_mask:0xf
    v_add_f32_dpp v50, v50, v50 row_ror:1 row_mask:0xf bank_mask:0xf
    v_add_f32_dpp v51, v51, v51 row_ror:1 row_mask:0xf bank_mask:0xf
    ds_write_b128 v82, v[48:51]
    s_add_u32 s97, s43, 1
    s_and_b32 s97, s97, 15
    s_mul_i32 s4, s97, 114688
    s_add_u32 m0, s7, 16384
    s_add_u32 s5, s4, 56320
    buffer_load_dwordx4 v7, s[12:15], s4 offen offset:2048 lds
    buffer_load_dwordx4 v7, s[12:15], s5 offen offset:3072 lds
    s_waitcnt lgkmcnt(0)
    s_barrier
    ds_read2_b32 v[48:49], v83 offset0:0 offset1:8
    ds_read2_b32 v[50:51], v83 offset0:16 offset1:24
    ds_read2_b32 v[52:53], v83 offset0:32 offset1:40
    ds_read2_b32 v[54:55], v83 offset0:48 offset1:56
    s_add_u32 s97, s43, 2
    s_and_b32 s97, s97, 15
    s_lshl_b32 s4, s97, 6
    s_add_u32 m0, s7, 32768
    s_add_u32 s5, s4, 15360
    buffer_load_dwordx4 v5, s[8:11], s4 offen lds
    buffer_load_dwordx4 v5, s[8:11], s5 offen offset:1024 lds
    s_add_u32 m0, s7, 49152
    s_add_u32 s4, s4, 64
    s_add_u32 s5, s5, 64
    buffer_load_dwordx4 v5, s[8:11], s4 offen lds
    buffer_load_dwordx4 v5, s[8:11], s5 offen offset:1024 lds
    s_add_u32 s97, s43, 2
    s_and_b32 s97, s97, 15
    s_mul_i32 s4, s97, 114688
    s_add_u32 m0, s7, 32768
    s_add_u32 s5, s4, 56320
    buffer_load_dwordx4 v7, s[12:15], s4 offen offset:2048 lds
    buffer_load_dwordx4 v7, s[12:15], s5 offen offset:3072 lds
    s_add_u32 s97, s43, 3
    s_and_b32 s97, s97, 15
    s_mul_i32 s4, s97, 114688
    s_add_u32 m0, s7, 49152
    s_add_u32 s5, s4, 56320
    buffer_load_dwordx4 v7, s[12:15], s4 offen offset:2048 lds
    buffer_load_dwordx4 v7, s[12:15], s5 offen offset:3072 lds
    v_mov_b32 v126, 0
    buffer_load_dword v124, v126, s[28:31], 0 offen sc1
    s_waitcnt lgkmcnt(0)
    s_waitcnt vmcnt(11)
    ds_read_b64_tr_b16 v[64:65], v80 offset:0
    ds_read_b64_tr_b16 v[66:67], v80 offset:2048
    ds_read_b64_tr_b16 v[68:69], v80 offset:8
    ds_read_b64_tr_b16 v[70:71], v80 offset:2056
    ds_read_b64_tr_b16 v[72:73], v81 offset:0
    ds_read_b64_tr_b16 v[74:75], v81 offset:2048
    ds_read_b64_tr_b16 v[76:77], v81 offset:8
    ds_read_b64_tr_b16 v[78:79], v81 offset:2056
    v_pk_add_f32 v[48:49], v[48:49], v[50:51]
    v_pk_add_f32 v[52:53], v[52:53], v[54:55]
    v_pk_add_f32 v[48:49], v[48:49], v[52:53]
    v_mul_f32 v48, 0x3b000000, v48
    v_mul_f32 v49, 0x3b000000, v49
    v_fma_f32 v49, -v48, v48, v49
    v_max_f32 v49, 0, v49
    v_cvt_pk_bf16_f32 v50, v48, v49
    v_lshlrev_b32 v48, 16, v50
    v_and_b32 v49, 0xffff0000, v50
    v_add_f32 v49, 0x3727c5ac, v49
    v_cvt_pk_bf16_f32 v49, v49, v49
    v_and_b32 v49, 0xffff0000, v49
    v_sqrt_f32 v49, v49
    s_nop 0
    v_cvt_pk_bf16_f32 v49, v49, v49
    v_and_b32 v49, 0xffff0000, v49
    v_rcp_f32 v50, v49
    s_nop 0
    v_fma_f32 v51, -v49, v50, 1.0
    v_fma_f32 v51, v51, v50, v50
    v_sub_f32 v50, 0, v48
    v_readlane_b32 s44, v48, 0
    v_readlane_b32 s52, v51, 0
    v_readlane_b32 s45, v48, 1
    v_readlane_b32 s53, v51, 1
    v_readlane_b32 s46, v48, 2
    v_readlane_b32 s54, v51, 2
    v_readlane_b32 s47, v48, 3
    v_readlane_b32 s55, v51, 3
    v_readlane_b32 s48, v48, 4
    v_readlane_b32 s56, v51, 4
    v_readlane_b32 s49, v48, 5
    v_readlane_b32 s57, v51, 5
    v_readlane_b32 s50, v48, 6
    v_readlane_b32 s58, v51, 6
    v_readlane_b32 s51, v48, 7
    v_readlane_b32 s59, v51, 7
    s_mov_b64 exec, 0xff
    buffer_store_dwordx2 v[50:51], v84, s[16:19], s89 offen sc1
    s_mov_b64 exec, -1
    v_pk_add_f32 v[32:33], v[32:33], s[44:45] neg_lo:[0,1] neg_hi:[0,1]
    v_pk_add_f32 v[34:35], v[34:35], s[46:47] neg_lo:[0,1] neg_hi:[0,1]
    v_pk_add_f32 v[36:37], v[36:37], s[48:49] neg_lo:[0,1] neg_hi:[0,1]
    v_pk_add_f32 v[38:39], v[38:39], s[50:51] neg_lo:[0,1] neg_hi:[0,1]
    v_pk_mul_f32 v[32:33], v[32:33], s[52:53]
    v_pk_mul_f32 v[34:35], v[34:35], s[54:55]
    v_pk_mul_f32 v[36:37], v[36:37], s[56:57]
    v_pk_mul_f32 v[38:39], v[38:39], s[58:59]
    v_cvt_pk_bf16_f32 v16, v32, v33
    v_cvt_pk_bf16_f32 v17, v34, v35
    v_cvt_pk_bf16_f32 v18, v36, v37
    v_cvt_pk_bf16_f32 v19, v38, v39
    buffer_store_dwordx4 v[16:19], v15, s[16:19], s80 offen sc1
    v_pk_add_f32 v[40:41], v[40:41], s[44:45] neg_lo:[0,1] neg_hi:[0,1]
    v_pk_add_f32 v[42:43], v[42:43], s[46:47] neg_lo:[0,1] neg_hi:[0,1]
    v_pk_add_f32 v[44:45], v[44:45], s[48:49] neg_lo:[0,1] neg_hi:[0,1]
    v_pk_add_f32 v[46:47], v[46:47], s[50:51] neg_lo:[0,1] neg_hi:[0,1]
    v_pk_mul_f32 v[40:41], v[40:41], s[52:53]
    v_pk_mul_f32 v[42:43], v[42:43], s[54:55]
    v_pk_mul_f32 v[44:45], v[44:45], s[56:57]
    v_pk_mul_f32 v[46:47], v[46:47], s[58:59]
    v_cvt_pk_bf16_f32 v20, v40, v41
    v_cvt_pk_bf16_f32 v21, v42, v43
    v_cvt_pk_bf16_f32 v22, v44, v45
    v_cvt_pk_bf16_f32 v23, v46, v47
    s_add_u32 s80, s80, 4096
    buffer_store_dwordx4 v[20:23], v15, s[16:19], s80 offen sc1
    s_waitcnt lgkmcnt(0)
    buffer_store_dwordx4 v[64:67], v15, s[16:19], s79 offen offset:0 sc1
    buffer_store_dwordx4 v[68:71], v15, s[16:19], s79 offen offset:1024 sc1
    buffer_store_dwordx4 v[72:75], v15, s[16:19], s79 offen offset:2048 sc1
    buffer_store_dwordx4 v[76:79], v15, s[16:19], s79 offen offset:3072 sc1
    s_barrier
    ds_read_b128 a[0:3], v9 offset:0
    ds_read_b128 a[4:7], v9 offset:1024
    ds_read_b64_tr_b16 a[16:17], v112 offset:0
    ds_read_b64_tr_b16 a[18:19], v112 offset:256
    ds_read_b64_tr_b16 a[20:21], v113 offset:0
    ds_read_b64_tr_b16 a[22:23], v113 offset:256
    ds_read_b64_tr_b16 a[24:25], v114 offset:0
    ds_read_b64_tr_b16 a[26:27], v114 offset:256
    ds_read_b64_tr_b16 a[28:29], v115 offset:0
    ds_read_b64_tr_b16 a[30:31], v115 offset:256
    ds_read_b64_tr_b16 a[32:33], v116 offset:0
    ds_read_b64_tr_b16 a[34:35], v116 offset:256
    ds_read_b64_tr_b16 a[36:37], v117 offset:0
    ds_read_b64_tr_b16 a[38:39], v117 offset:256
    ds_read_b64_tr_b16 a[40:41], v118 offset:0
    ds_read_b64_tr_b16 a[42:43], v118 offset:256
    s_waitcnt vmcnt(16)
    s_waitcnt lgkmcnt(0)
    s_barrier
    v_mfma_f32_16x16x32_bf16 v[16:19], a[16:19], a[0:3], 0
    ds_read_b128 a[8:11], v9 offset:16384
    ds_read_b128 a[12:15], v9 offset:17408
    v_mfma_f32_16x16x32_bf16 v[20:23], a[16:19], a[4:7], 0
    ds_read_b64_tr_b16 a[44:45], v112 offset:16384
    ds_read_b64_tr_b16 a[46:47], v112 offset:16640
    v_mfma_f32_16x16x32_bf16 v[24:27], a[20:23], a[0:3], 0
    ds_read_b64_tr_b16 a[48:49], v113 offset:16384
    ds_read_b64_tr_b16 a[50:51], v113 offset:16640
    v_mfma_f32_16x16x32_bf16 v[28:31], a[20:23], a[4:7], 0
    ds_read_b64_tr_b16 a[52:53], v114 offset:16384
    ds_read_b64_tr_b16 a[54:55], v114 offset:16640
    v_mfma_f32_16x16x32_bf16 v[32:35], a[24:27], a[0:3], 0
    ds_read_b64_tr_b16 a[56:57], v115 offset:16384
    ds_read_b64_tr_b16 a[58:59], v115 offset:16640
    v_mfma_f32_16x16x32_bf16 v[36:39], a[24:27], a[4:7], 0
    ds_read_b64_tr_b16 a[60:61], v116 offset:16384
    ds_read_b64_tr_b16 a[62:63], v116 offset:16640
    v_mfma_f32_16x16x32_bf16 v[40:43], a[28:31], a[0:3], 0
    ds_read_b64_tr_b16 a[64:65], v117 offset:16384
    ds_read_b64_tr_b16 a[66:67], v117 offset:16640
    v_mfma_f32_16x16x32_bf16 v[44:47], a[28:31], a[4:7], 0
    ds_read_b64_tr_b16 a[68:69], v118 offset:16384
    ds_read_b64_tr_b16 a[70:71], v118 offset:16640
    v_mfma_f32_16x16x32_bf16 v[48:51], a[32:35], a[0:3], 0
    v_mfma_f32_4x4x4_16b_bf16 v[72:75], a[16:17], v[120:121], 0
    v_mfma_f32_4x4x4_16b_bf16 v[76:79], a[20:21], v[120:121], 0
    v_mfma_f32_16x16x32_bf16 v[52:55], a[32:35], a[4:7], 0
    v_mfma_f32_4x4x4_16b_bf16 v[80:83], a[40:41], v[120:121], 0
    v_mfma_f32_4x4x4_16b_bf16 v[72:75], a[18:19], v[120:121], v[72:75]
    v_mfma_f32_16x16x32_bf16 v[56:59], a[36:39], a[0:3], 0
    v_mfma_f32_4x4x4_16b_bf16 v[76:79], a[22:23], v[120:121], v[76:79]
    v_mfma_f32_4x4x4_16b_bf16 v[80:83], a[42:43], v[120:121], v[80:83]
    v_mfma_f32_16x16x32_bf16 v[60:63], a[36:39], a[4:7], 0
    v_mfma_f32_16x16x32_bf16 v[64:67], a[40:43], a[0:3], 0
    v_mfma_f32_16x16x32_bf16 v[68:71], a[40:43], a[4:7], 0
    s_waitcnt vmcnt(10)
    s_waitcnt lgkmcnt(0)
    s_barrier
    v_mfma_f32_16x16x32_bf16 v[16:19], a[44:47], a[8:11], v[16:19]
    ds_read_b128 a[0:3], v9 offset:32768
    ds_read_b128 a[4:7], v9 offset:33792
    v_mfma_f32_16x16x32_bf16 v[20:23], a[44:47], a[12:15], v[20:23]
    ds_read_b64_tr_b16 a[16:17], v112 offset:32768
    ds_read_b64_tr_b16 a[18:19], v112 offset:33024
    v_mfma_f32_16x16x32_bf16 v[24:27], a[48:51], a[8:11], v[24:27]
    ds_read_b64_tr_b16 a[20:21], v113 offset:32768
    ds_read_b64_tr_b16 a[22:23], v113 offset:33024
    v_mfma_f32_16x16x32_bf16 v[28:31], a[48:51], a[12:15], v[28:31]
    ds_read_b64_tr_b16 a[24:25], v114 offset:32768
    ds_read_b64_tr_b16 a[26:27], v114 offset:33024
    v_mfma_f32_16x16x32_bf16 v[32:35], a[52:55], a[8:11], v[32:35]
    ds_read_b64_tr_b16 a[28:29], v115 offset:32768
    ds_read_b64_tr_b16 a[30:31], v115 offset:33024
    v_mfma_f32_16x16x32_bf16 v[36:39], a[52:55], a[12:15], v[36:39]
    ds_read_b64_tr_b16 a[32:33], v116 offset:32768
    ds_read_b64_tr_b16 a[34:35], v116 offset:33024
    v_mfma_f32_16x16x32_bf16 v[40:43], a[56:59], a[8:11], v[40:43]
    ds_read_b64_tr_b16 a[36:37], v117 offset:32768
    ds_read_b64_tr_b16 a[38:39], v117 offset:33024
    v_mfma_f32_16x16x32_bf16 v[44:47], a[56:59], a[12:15], v[44:47]
    ds_read_b64_tr_b16 a[40:41], v118 offset:32768
    ds_read_b64_tr_b16 a[42:43], v118 offset:33024
    v_mfma_f32_16x16x32_bf16 v[48:51], a[60:63], a[8:11], v[48:51]
    v_mfma_f32_4x4x4_16b_bf16 v[72:75], a[44:45], v[120:121], v[72:75]
    v_mfma_f32_4x4x4_16b_bf16 v[76:79], a[48:49], v[120:121], v[76:79]
    v_mfma_f32_16x16x32_bf16 v[52:55], a[60:63], a[12:15], v[52:55]
    v_mfma_f32_4x4x4_16b_bf16 v[80:83], a[68:69], v[120:121], v[80:83]
    v_mfma_f32_4x4x4_16b_bf16 v[72:75], a[46:47], v[120:121], v[72:75]
    v_mfma_f32_16x16x32_bf16 v[56:59], a[64:67], a[8:11], v[56:59]
    v_mfma_f32_4x4x4_16b_bf16 v[76:79], a[50:51], v[120:121], v[76:79]
    v_mfma_f32_4x4x4_16b_bf16 v[80:83], a[70:71], v[120:121], v[80:83]
    v_mfma_f32_16x16x32_bf16 v[60:63], a[64:67], a[12:15], v[60:63]
    v_mfma_f32_16x16x32_bf16 v[64:67], a[68:71], a[8:11], v[64:67]
    v_mfma_f32_16x16x32_bf16 v[68:71], a[68:71], a[12:15], v[68:71]
    s_waitcnt vmcnt(8)
    s_waitcnt vmcnt(0)
    s_waitcnt lgkmcnt(0)
    s_barrier
    v_mfma_f32_16x16x32_bf16 v[16:19], a[16:19], a[0:3], v[16:19]
    ds_read_b128 a[8:11], v9 offset:49152
    ds_read_b128 a[12:15], v9 offset:50176
    v_mfma_f32_16x16x32_bf16 v[20:23], a[16:19], a[4:7], v[20:23]
    ds_read_b64_tr_b16 a[44:45], v112 offset:49152
    ds_read_b64_tr_b16 a[46:47], v112 offset:49408
    v_mfma_f32_16x16x32_bf16 v[24:27], a[20:23], a[0:3], v[24:27]
    ds_read_b64_tr_b16 a[48:49], v113 offset:49152
    ds_read_b64_tr_b16 a[50:51], v113 offset:49408
    v_mfma_f32_16x16x32_bf16 v[28:31], a[20:23], a[4:7], v[28:31]
    ds_read_b64_tr_b16 a[52:53], v114 offset:49152
    ds_read_b64_tr_b16 a[54:55], v114 offset:49408
    v_mfma_f32_16x16x32_bf16 v[32:35], a[24:27], a[0:3], v[32:35]
    ds_read_b64_tr_b16 a[56:57], v115 offset:49152
    ds_read_b64_tr_b16 a[58:59], v115 offset:49408
    v_mfma_f32_16x16x32_bf16 v[36:39], a[24:27], a[4:7], v[36:39]
    ds_read_b64_tr_b16 a[60:61], v116 offset:49152
    ds_read_b64_tr_b16 a[62:63], v116 offset:49408
    v_mfma_f32_16x16x32_bf16 v[40:43], a[28:31], a[0:3], v[40:43]
    ds_read_b64_tr_b16 a[64:65], v117 offset:49152
    ds_read_b64_tr_b16 a[66:67], v117 offset:49408
    v_mfma_f32_16x16x32_bf16 v[44:47], a[28:31], a[4:7], v[44:47]
    ds_read_b64_tr_b16 a[68:69], v118 offset:49152
    ds_read_b64_tr_b16 a[70:71], v118 offset:49408
    v_mfma_f32_16x16x32_bf16 v[48:51], a[32:35], a[0:3], v[48:51]
    v_mfma_f32_4x4x4_16b_bf16 v[72:75], a[16:17], v[120:121], v[72:75]
    v_mfma_f32_4x4x4_16b_bf16 v[76:79], a[20:21], v[120:121], v[76:79]
    v_mfma_f32_16x16x32_bf16 v[52:55], a[32:35], a[4:7], v[52:55]
    v_mfma_f32_4x4x4_16b_bf16 v[80:83], a[40:41], v[120:121], v[80:83]
    v_mfma_f32_4x4x4_16b_bf16 v[72:75], a[18:19], v[120:121], v[72:75]
    v_mfma_f32_16x16x32_bf16 v[56:59], a[36:39], a[0:3], v[56:59]
    v_mfma_f32_4x4x4_16b_bf16 v[76:79], a[22:23], v[120:121], v[76:79]
    v_mfma_f32_4x4x4_16b_bf16 v[80:83], a[42:43], v[120:121], v[80:83]
    v_mfma_f32_16x16x32_bf16 v[60:63], a[36:39], a[4:7], v[60:63]
    s_mov_b32 s96, 0
L_chk5:
    v_readfirstlane_b32 s41, v124
    s_nop 0
    s_cmp_lg_u32 s41, 0
    s_cbranch_scc1 L_ok5
    s_sleep 1
    v_mov_b32 v125, 0
    buffer_load_dword v124, v125, s[28:31], 0 offen sc1
    s_waitcnt vmcnt(0)
    s_add_u32 s96, s96, 1
    s_cmp_lt_u32 s96, 0x20000
    s_cbranch_scc1 L_chk5
L_ok5:
    v_mov_b32 v125, 0
    v_mov_b32 v126, s41
    s_mov_b64 exec, 1
    buffer_store_dword v126, v125, s[16:19], s94 offen sc1
    s_mov_b64 exec, -1
    v_mfma_f32_16x16x32_bf16 v[64:67], a[40:43], a[0:3], v[64:67]
    v_mfma_f32_16x16x32_bf16 v[68:71], a[40:43], a[4:7], v[68:71]
    s_waitcnt lgkmcnt(0)
    s_barrier
    v_mfma_f32_16x16x32_bf16 v[16:19], a[44:47], a[8:11], v[16:19]
    ds_read_b128 a[0:3], v9 offset:0
    ds_read_b128 a[4:7], v9 offset:1024
    v_mfma_f32_16x16x32_bf16 v[20:23], a[44:47], a[12:15], v[20:23]
    ds_read_b64_tr_b16 a[16:17], v112 offset:0
    ds_read_b64_tr_b16 a[18:19], v112 offset:256
    v_mfma_f32_16x16x32_bf16 v[24:27], a[48:51], a[8:11], v[24:27]
    ds_read_b64_tr_b16 a[20:21], v113 offset:0
    ds_read_b64_tr_b16 a[22:23], v113 offset:256
    v_mfma_f32_16x16x32_bf16 v[28:31], a[48:51], a[12:15], v[28:31]
    ds_read_b64_tr_b16 a[24:25], v114 offset:0
    ds_read_b64_tr_b16 a[26:27], v114 offset:256
    v_mfma_f32_16x16x32_bf16 v[32:35], a[52:55], a[8:11], v[32:35]
    ds_read_b64_tr_b16 a[28:29], v115 offset:0
    ds_read_b64_tr_b16 a[30:31], v115 offset:256
    v_mfma_f32_16x16x32_bf16 v[36:39], a[52:55], a[12:15], v[36:39]
    ds_read_b64_tr_b16 a[32:33], v116 offset:0
    ds_read_b64_tr_b16 a[34:35], v116 offset:256
    v_mfma_f32_16x16x32_bf16 v[40:43], a[56:59], a[8:11], v[40:43]
    ds_read_b64_tr_b16 a[36:37], v117 offset:0
    ds_read_b64_tr_b16 a[38:39], v117 offset:256
    v_mfma_f32_16x16x32_bf16 v[44:47], a[56:59], a[12:15], v[44:47]
    ds_read_b64_tr_b16 a[40:41], v118 offset:0
    ds_read_b64_tr_b16 a[42:43], v118 offset:256
    v_mfma_f32_16x16x32_bf16 v[48:51], a[60:63], a[8:11], v[48:51]
    v_mfma_f32_4x4x4_16b_bf16 v[72:75], a[44:45], v[120:121], v[72:75]
    v_mfma_f32_4x4x4_16b_bf16 v[76:79], a[48:49], v[120:121], v[76:79]
    v_mfma_f32_16x16x32_bf16 v[52:55], a[60:63], a[12:15], v[52:55]
    v_mfma_f32_4x4x4_16b_bf16 v[80:83], a[68:69], v[120:121], v[80:83]
    v_mfma_f32_4x4x4_16b_bf16 v[72:75], a[46:47], v[120:121], v[72:75]
    v_mfma_f32_16x16x32_bf16 v[56:59], a[64:67], a[8:11], v[56:59]
    v_mfma_f32_4x4x4_16b_bf16 v[76:79], a[50:51], v[120:121], v[76:79]
    v_mfma_f32_4x4x4_16b_bf16 v[80:83], a[70:71], v[120:121], v[80:83]
    v_mfma_f32_16x16x32_bf16 v[60:63], a[64:67], a[12:15], v[60:63]
    v_mfma_f32_16x16x32_bf16 v[64:67], a[68:71], a[8:11], v[64:67]
    v_mfma_f32_16x16x32_bf16 v[68:71], a[68:71], a[12:15], v[68:71]
    s_waitcnt lgkmcnt(0)
    s_barrier
    v_mfma_f32_16x16x32_bf16 v[16:19], a[16:19], a[0:3], v[16:19]
    ds_read_b128 a[8:11], v9 offset:16384
    ds_read_b128 a[12:15], v9 offset:17408
    v_mfma_f32_16x16x32_bf16 v[20:23], a[16:19], a[4:7], v[20:23]
    ds_read_b64_tr_b16 a[44:45], v112 offset:16384
    ds_read_b64_tr_b16 a[46:47], v112 offset:16640
    v_mfma_f32_16x16x32_bf16 v[24:27], a[20:23], a[0:3], v[24:27]
    ds_read_b64_tr_b16 a[48:49], v113 offset:16384
    ds_read_b64_tr_b16 a[50:51], v113 offset:16640
    v_mfma_f32_16x16x32_bf16 v[28:31], a[20:23], a[4:7], v[28:31]
    ds_read_b64_tr_b16 a[52:53], v114 offset:16384
    ds_read_b64_tr_b16 a[54:55], v114 offset:16640
    v_mfma_f32_16x16x32_bf16 v[32:35], a[24:27], a[0:3], v[32:35]
    ds_read_b64_tr_b16 a[56:57], v115 offset:16384
    ds_read_b64_tr_b16 a[58:59], v115 offset:16640
    v_mfma_f32_16x16x32_bf16 v[36:39], a[24:27], a[4:7], v[36:39]
    ds_read_b64_tr_b16 a[60:61], v116 offset:16384
    ds_read_b64_tr_b16 a[62:63], v116 offset:16640
    v_mfma_f32_16x16x32_bf16 v[40:43], a[28:31], a[0:3], v[40:43]
    ds_read_b64_tr_b16 a[64:65], v117 offset:16384
    ds_read_b64_tr_b16 a[66:67], v117 offset:16640
    v_mfma_f32_16x16x32_bf16 v[44:47], a[28:31], a[4:7], v[44:47]
    ds_read_b64_tr_b16 a[68:69], v118 offset:16384
    ds_read_b64_tr_b16 a[70:71], v118 offset:16640
    v_mfma_f32_16x16x32_bf16 v[48:51], a[32:35], a[0:3], v[48:51]
    v_mfma_f32_4x4x4_16b_bf16 v[72:75], a[16:17], v[120:121], v[72:75]
    v_mfma_f32_4x4x4_16b_bf16 v[76:79], a[20:21], v[120:121], v[76:79]
    v_mfma_f32_16x16x32_bf16 v[52:55], a[32:35], a[4:7], v[52:55]
    v_mfma_f32_4x4x4_16b_bf16 v[80:83], a[40:41], v[120:121], v[80:83]
    v_mfma_f32_4x4x4_16b_bf16 v[72:75], a[18:19], v[120:121], v[72:75]
    v_mfma_f32_16x16x32_bf16 v[56:59], a[36:39], a[0:3], v[56:59]
    v_mfma_f32_4x4x4_16b_bf16 v[76:79], a[22:23], v[120:121], v[76:79]
    v_mfma_f32_4x4x4_16b_bf16 v[80:83], a[42:43], v[120:121], v[80:83]
    v_mfma_f32_16x16x32_bf16 v[60:63], a[36:39], a[4:7], v[60:63]
    v_mfma_f32_16x16x32_bf16 v[64:67], a[40:43], a[0:3], v[64:67]
    v_mfma_f32_16x16x32_bf16 v[68:71], a[40:43], a[4:7], v[68:71]
    s_waitcnt lgkmcnt(0)
    s_barrier
    v_mfma_f32_16x16x32_bf16 v[16:19], a[44:47], a[8:11], v[16:19]
    ds_read_b128 a[0:3], v9 offset:32768
    ds_read_b128 a[4:7], v9 offset:33792
    v_mfma_f32_16x16x32_bf16 v[20:23], a[44:47], a[12:15], v[20:23]
    ds_read_b64_tr_b16 a[16:17], v112 offset:32768
    ds_read_b64_tr_b16 a[18:19], v112 offset:33024
    v_mfma_f32_16x16x32_bf16 v[24:27], a[48:51], a[8:11], v[24:27]
    ds_read_b64_tr_b16 a[20:21], v113 offset:32768
    ds_read_b64_tr_b16 a[22:23], v113 offset:33024
    v_mfma_f32_16x16x32_bf16 v[28:31], a[48:51], a[12:15], v[28:31]
    ds_read_b64_tr_b16 a[24:25], v114 offset:32768
    ds_read_b64_tr_b16 a[26:27], v114 offset:33024
    v_mfma_f32_16x16x32_bf16 v[32:35], a[52:55], a[8:11], v[32:35]
    ds_read_b64_tr_b16 a[28:29], v115 offset:32768
    ds_read_b64_tr_b16 a[30:31], v115 offset:33024
    v_mfma_f32_16x16x32_bf16 v[36:39], a[52:55], a[12:15], v[36:39]
    ds_read_b64_tr_b16 a[32:33], v116 offset:32768
    ds_read_b64_tr_b16 a[34:35], v116 offset:33024
    v_mfma_f32_16x16x32_bf16 v[40:43], a[56:59], a[8:11], v[40:43]
    ds_read_b64_tr_b16 a[36:37], v117 offset:32768
    ds_read_b64_tr_b16 a[38:39], v117 offset:33024
    v_mfma_f32_16x16x32_bf16 v[44:47], a[56:59], a[12:15], v[44:47]
    ds_read_b64_tr_b16 a[40:41], v118 offset:32768
    ds_read_b64_tr_b16 a[42:43], v118 offset:33024
    v_mfma_f32_16x16x32_bf16 v[48:51], a[60:63], a[8:11], v[48:51]
    v_mfma_f32_4x4x4_16b_bf16 v[72:75], a[44:45], v[120:121], v[72:75]
    v_mfma_f32_4x4x4_16b_bf16 v[76:79], a[48:49], v[120:121], v[76:79]
    v_mfma_f32_16x16x32_bf16 v[52:55], a[60:63], a[12:15], v[52:55]
    v_mfma_f32_4x4x4_16b_bf16 v[80:83], a[68:69], v[120:121], v[80:83]
    v_mfma_f32_4x4x4_16b_bf16 v[72:75], a[46:47], v[120:121], v[72:75]
    v_mfma_f32_16x16x32_bf16 v[56:59], a[64:67], a[8:11], v[56:59]
    v_mfma_f32_4x4x4_16b_bf16 v[76:79], a[50:51], v[120:121], v[76:79]
    v_mfma_f32_4x4x4_16b_bf16 v[80:83], a[70:71], v[120:121], v[80:83]
    v_mfma_f32_16x16x32_bf16 v[60:63], a[64:67], a[12:15], v[60:63]
    v_mfma_f32_16x16x32_bf16 v[64:67], a[68:71], a[8:11], v[64:67]
    v_mfma_f32_16x16x32_bf16 v[68:71], a[68:71], a[12:15], v[68:71]
    s_waitcnt lgkmcnt(0)
    s_barrier
    v_mfma_f32_16x16x32_bf16 v[16:19], a[16:19], a[0:3], v[16:19]
    ds_read_b128 a[8:11], v9 offset:49152
    ds_read_b128 a[12:15], v9 offset:50176
    v_mfma_f32_16x16x32_bf16 v[20:23], a[16:19], a[4:7], v[20:23]
    ds_read_b64_tr_b16 a[44:45], v112 offset:49152
    ds_read_b64_tr_b16 a[46:47], v112 offset:49408
    v_mfma_f32_16x16x32_bf16 v[24:27], a[20:23], a[0:3], v[24:27]
    ds_read_b64_tr_b16 a[48:49], v113 offset:49152
    ds_read_b64_tr_b16 a[50:51], v113 offset:49408
    v_mfma_f32_16x16x32_bf16 v[28:31], a[20:23], a[4:7], v[28:31]
    ds_read_b64_tr_b16 a[52:53], v114 offset:49152
    ds_read_b64_tr_b16 a[54:55], v114 offset:49408
    v_mfma_f32_16x16x32_bf16 v[32:35], a[24:27], a[0:3], v[32:35]
    ds_read_b64_tr_b16 a[56:57], v115 offset:49152
    ds_read_b64_tr_b16 a[58:59], v115 offset:49408
    v_mfma_f32_16x16x32_bf16 v[36:39], a[24:27], a[4:7], v[36:39]
    ds_read_b64_tr_b16 a[60:61], v116 offset:49152
    ds_read_b64_tr_b16 a[62:63], v116 offset:49408
    v_mfma_f32_16x16x32_bf16 v[40:43], a[28:31], a[0:3], v[40:43]
    ds_read_b64_tr_b16 a[64:65], v117 offset:49152
    ds_read_b64_tr_b16 a[66:67], v117 offset:49408
    v_mfma_f32_16x16x32_bf16 v[44:47], a[28:31], a[4:7], v[44:47]
    ds_read_b64_tr_b16 a[68:69], v118 offset:49152
    ds_read_b64_tr_b16 a[70:71], v118 offset:49408
    v_mfma_f32_16x16x32_bf16 v[48:51], a[32:35], a[0:3], v[48:51]
    v_mfma_f32_4x4x4_16b_bf16 v[72:75], a[16:17], v[120:121], v[72:75]
    v_mfma_f32_4x4x4_16b_bf16 v[76:79], a[20:21], v[120:121], v[76:79]
    v_mfma_f32_16x16x32_bf16 v[52:55], a[32:35], a[4:7], v[52:55]
    v_mfma_f32_4x4x4_16b_bf16 v[80:83], a[40:41], v[120:121], v[80:83]
    v_mfma_f32_4x4x4_16b_bf16 v[72:75], a[18:19], v[120:121], v[72:75]
    v_mfma_f32_16x16x32_bf16 v[56:59], a[36:39], a[0:3], v[56:59]
    v_mfma_f32_4x4x4_16b_bf16 v[76:79], a[22:23], v[120:121], v[76:79]
    v_mfma_f32_4x4x4_16b_bf16 v[80:83], a[42:43], v[120:121], v[80:83]
    v_mfma_f32_16x16x32_bf16 v[60:63], a[36:39], a[4:7], v[60:63]
    v_mfma_f32_16x16x32_bf16 v[64:67], a[40:43], a[0:3], v[64:67]
    v_mfma_f32_16x16x32_bf16 v[68:71], a[40:43], a[4:7], v[68:71]
    s_waitcnt lgkmcnt(0)
    s_barrier
    v_mfma_f32_16x16x32_bf16 v[16:19], a[44:47], a[8:11], v[16:19]
    ds_read_b128 a[0:3], v9 offset:0
    ds_read_b128 a[4:7], v9 offset:1024
    v_mfma_f32_16x16x32_bf16 v[20:23], a[44:47], a[12:15], v[20:23]
    ds_read_b64_tr_b16 a[16:17], v112 offset:0
    ds_read_b64_tr_b16 a[18:19], v112 offset:256
    v_mfma_f32_16x16x32_bf16 v[24:27], a[48:51], a[8:11], v[24:27]
    ds_read_b64_tr_b16 a[20:21], v113 offset:0
    ds_read_b64_tr_b16 a[22:23], v113 offset:256
    v_mfma_f32_16x16x32_bf16 v[28:31], a[48:51], a[12:15], v[28:31]
    ds_read_b64_tr_b16 a[24:25], v114 offset:0
    ds_read_b64_tr_b16 a[26:27], v114 offset:256
    v_mfma_f32_16x16x32_bf16 v[32:35], a[52:55], a[8:11], v[32:35]
    ds_read_b64_tr_b16 a[28:29], v115 offset:0
    ds_read_b64_tr_b16 a[30:31], v115 offset:256
    v_mfma_f32_16x16x32_bf16 v[36:39], a[52:55], a[12:15], v[36:39]
    ds_read_b64_tr_b16 a[32:33], v116 offset:0
    ds_read_b64_tr_b16 a[34:35], v116 offset:256
    v_mfma_f32_16x16x32_bf16 v[40:43], a[56:59], a[8:11], v[40:43]
    ds_read_b64_tr_b16 a[36:37], v117 offset:0
    ds_read_b64_tr_b16 a[38:39], v117 offset:256
    v_mfma_f32_16x16x32_bf16 v[44:47], a[56:59], a[12:15], v[44:47]
    ds_read_b64_tr_b16 a[40:41], v118 offset:0
    ds_read_b64_tr_b16 a[42:43], v118 offset:256
    v_mfma_f32_16x16x32_bf16 v[48:51], a[60:63], a[8:11], v[48:51]
    v_mfma_f32_4x4x4_16b_bf16 v[72:75], a[44:45], v[120:121], v[72:75]
    v_mfma_f32_4x4x4_16b_bf16 v[76:79], a[48:49], v[120:121], v[76:79]
    v_mfma_f32_16x16x32_bf16 v[52:55], a[60:63], a[12:15], v[52:55]
    v_mfma_f32_4x4x4_16b_bf16 v[80:83], a[68:69], v[120:121], v[80:83]
    v_mfma_f32_4x4x4_16b_bf16 v[72:75], a[46:47], v[120:121], v[72:75]
    v_mfma_f32_16x16x32_bf16 v[56:59], a[64:67], a[8:11], v[56:59]
    v_mfma_f32_4x4x4_16b_bf16 v[76:79], a[50:51], v[120:121], v[76:79]
    v_mfma_f32_4x4x4_16b_bf16 v[80:83], a[70:71], v[120:121], v[80:83]
    v_mfma_f32_16x16x32_bf16 v[60:63], a[64:67], a[12:15], v[60:63]
    v_mfma_f32_16x16x32_bf16 v[64:67], a[68:71], a[8:11], v[64:67]
    v_mfma_f32_16x16x32_bf16 v[68:71], a[68:71], a[12:15], v[68:71]
    s_waitcnt lgkmcnt(0)
    s_barrier
    v_mfma_f32_16x16x32_bf16 v[16:19], a[16:19], a[0:3], v[16:19]
    ds_read_b128 a[8:11], v9 offset:16384
    ds_read_b128 a[12:15], v9 offset:17408
    v_mfma_f32_16x16x32_bf16 v[20:23], a[16:19], a[4:7], v[20:23]
    ds_read_b64_tr_b16 a[44:45], v112 offset:16384
    ds_read_b64_tr_b16 a[46:47], v112 offset:16640
    v_mfma_f32_16x16x32_bf16 v[24:27], a[20:23], a[0:3], v[24:27]
    ds_read_b64_tr_b16 a[48:49], v113 offset:16384
    ds_read_b64_tr_b16 a[50:51], v113 offset:16640
    v_mfma_f32_16x16x32_bf16 v[28:31], a[20:23], a[4:7], v[28:31]
    ds_read_b64_tr_b16 a[52:53], v114 offset:16384
    ds_read_b64_tr_b16 a[54:55], v114 offset:16640
    v_mfma_f32_16x16x32_bf16 v[32:35], a[24:27], a[0:3], v[32:35]
    ds_read_b64_tr_b16 a[56:57], v115 offset:16384
    ds_read_b64_tr_b16 a[58:59], v115 offset:16640
    v_mfma_f32_16x16x32_bf16 v[36:39], a[24:27], a[4:7], v[36:39]
    ds_read_b64_tr_b16 a[60:61], v116 offset:16384
    ds_read_b64_tr_b16 a[62:63], v116 offset:16640
    v_mfma_f32_16x16x32_bf16 v[40:43], a[28:31], a[0:3], v[40:43]
    ds_read_b64_tr_b16 a[64:65], v117 offset:16384
    ds_read_b64_tr_b16 a[66:67], v117 offset:16640
    v_mfma_f32_16x16x32_bf16 v[44:47], a[28:31], a[4:7], v[44:47]
    ds_read_b64_tr_b16 a[68:69], v118 offset:16384
    ds_read_b64_tr_b16 a[70:71], v118 offset:16640
    v_mfma_f32_16x16x32_bf16 v[48:51], a[32:35], a[0:3], v[48:51]
    v_mfma_f32_4x4x4_16b_bf16 v[72:75], a[16:17], v[120:121], v[72:75]
    v_mfma_f32_4x4x4_16b_bf16 v[76:79], a[20:21], v[120:121], v[76:79]
    v_mfma_f32_16x16x32_bf16 v[52:55], a[32:35], a[4:7], v[52:55]
    v_mfma_f32_4x4x4_16b_bf16 v[80:83], a[40:41], v[120:121], v[80:83]
    v_mfma_f32_4x4x4_16b_bf16 v[72:75], a[18:19], v[120:121], v[72:75]
    v_mfma_f32_16x16x32_bf16 v[56:59], a[36:39], a[0:3], v[56:59]
    v_mfma_f32_4x4x4_16b_bf16 v[76:79], a[22:23], v[120:121], v[76:79]
    v_mfma_f32_4x4x4_16b_bf16 v[80:83], a[42:43], v[120:121], v[80:83]
    v_mfma_f32_16x16x32_bf16 v[60:63], a[36:39], a[4:7], v[60:63]
    v_mfma_f32_16x16x32_bf16 v[64:67], a[40:43], a[0:3], v[64:67]
    v_mfma_f32_16x16x32_bf16 v[68:71], a[40:43], a[4:7], v[68:71]
    s_waitcnt lgkmcnt(0)
    s_barrier
    v_mfma_f32_16x16x32_bf16 v[16:19], a[44:47], a[8:11], v[16:19]
    ds_read_b128 a[0:3], v9 offset:32768
    ds_read_b128 a[4:7], v9 offset:33792
    v_mfma_f32_16x16x32_bf16 v[20:23], a[44:47], a[12:15], v[20:23]
    ds_read_b64_tr_b16 a[16:17], v112 offset:32768
    ds_read_b64_tr_b16 a[18:19], v112 offset:33024
    v_mfma_f32_16x16x32_bf16 v[24:27], a[48:51], a[8:11], v[24:27]
    ds_read_b64_tr_b16 a[20:21], v113 offset:32768
    ds_read_b64_tr_b16 a[22:23], v113 offset:33024
    v_mfma_f32_16x16x32_bf16 v[28:31], a[48:51], a[12:15], v[28:31]
    ds_read_b64_tr_b16 a[24:25], v114 offset:32768
    ds_read_b64_tr_b16 a[26:27], v114 offset:33024
    v_mfma_f32_16x16x32_bf16 v[32:35], a[52:55], a[8:11], v[32:35]
    ds_read_b64_tr_b16 a[28:29], v115 offset:32768
    ds_read_b64_tr_b16 a[30:31], v115 offset:33024
    v_mfma_f32_16x16x32_bf16 v[36:39], a[52:55], a[12:15], v[36:39]
    ds_read_b64_tr_b16 a[32:33], v116 offset:32768
    ds_read_b64_tr_b16 a[34:35], v116 offset:33024
    v_mfma_f32_16x16x32_bf16 v[40:43], a[56:59], a[8:11], v[40:43]
    ds_read_b64_tr_b16 a[36:37], v117 offset:32768
    ds_read_b64_tr_b16 a[38:39], v117 offset:33024
    v_mfma_f32_16x16x32_bf16 v[44:47], a[56:59], a[12:15], v[44:47]
    ds_read_b64_tr_b16 a[40:41], v118 offset:32768
    ds_read_b64_tr_b16 a[42:43], v118 offset:33024
    v_mfma_f32_16x16x32_bf16 v[48:51], a[60:63], a[8:11], v[48:51]
    v_mfma_f32_4x4x4_16b_bf16 v[72:75], a[44:45], v[120:121], v[72:75]
    v_mfma_f32_4x4x4_16b_bf16 v[76:79], a[48:49], v[120:121], v[76:79]
    v_mfma_f32_16x16x32_bf16 v[52:55], a[60:63], a[12:15], v[52:55]
    v_mfma_f32_4x4x4_16b_bf16 v[80:83], a[68:69], v[120:121], v[80:83]
    v_mfma_f32_4x4x4_16b_bf16 v[72:75], a[46:47], v[120:121], v[72:75]
    v_mfma_f32_16x16x32_bf16 v[56:59], a[64:67], a[8:11], v[56:59]
    v_mfma_f32_4x4x4_16b_bf16 v[76:79], a[50:51], v[120:121], v[76:79]
    v_mfma_f32_4x4x4_16b_bf16 v[80:83], a[70:71], v[120:121], v[80:83]
    v_mfma_f32_16x16x32_bf16 v[60:63], a[64:67], a[12:15], v[60:63]
    v_mfma_f32_16x16x32_bf16 v[64:67], a[68:71], a[8:11], v[64:67]
    v_mfma_f32_16x16x32_bf16 v[68:71], a[68:71], a[12:15], v[68:71]
    s_waitcnt lgkmcnt(0)
    s_barrier
    v_mfma_f32_16x16x32_bf16 v[16:19], a[16:19], a[0:3], v[16:19]
    ds_read_b128 a[8:11], v9 offset:49152
    ds_read_b128 a[12:15], v9 offset:50176
    v_mfma_f32_16x16x32_bf16 v[20:23], a[16:19], a[4:7], v[20:23]
    ds_read_b64_tr_b16 a[44:45], v112 offset:49152
    ds_read_b64_tr_b16 a[46:47], v112 offset:49408
    v_mfma_f32_16x16x32_bf16 v[24:27], a[20:23], a[0:3], v[24:27]
    ds_read_b64_tr_b16 a[48:49], v113 offset:49152
    ds_read_b64_tr_b16 a[50:51], v113 offset:49408
    v_mfma_f32_16x16x32_bf16 v[28:31], a[20:23], a[4:7], v[28:31]
    ds_read_b64_tr_b16 a[52:53], v114 offset:49152
    ds_read_b64_tr_b16 a[54:55], v114 offset:49408
    v_mfma_f32_16x16x32_bf16 v[32:35], a[24:27], a[0:3], v[32:35]
    ds_read_b64_tr_b16 a[56:57], v115 offset:49152
    ds_read_b64_tr_b16 a[58:59], v115 offset:49408
    v_mfma_f32_16x16x32_bf16 v[36:39], a[24:27], a[4:7], v[36:39]
    ds_read_b64_tr_b16 a[60:61], v116 offset:49152
    ds_read_b64_tr_b16 a[62:63], v116 offset:49408
    v_mfma_f32_16x16x32_bf16 v[40:43], a[28:31], a[0:3], v[40:43]
    ds_read_b64_tr_b16 a[64:65], v117 offset:49152
    ds_read_b64_tr_b16 a[66:67], v117 offset:49408
    v_mfma_f32_16x16x32_bf16 v[44:47], a[28:31], a[4:7], v[44:47]
    ds_read_b64_tr_b16 a[68:69], v118 offset:49152
    ds_read_b64_tr_b16 a[70:71], v118 offset:49408
    v_mfma_f32_16x16x32_bf16 v[48:51], a[32:35], a[0:3], v[48:51]
    v_mfma_f32_4x4x4_16b_bf16 v[72:75], a[16:17], v[120:121], v[72:75]
    v_mfma_f32_4x4x4_16b_bf16 v[76:79], a[20:21], v[120:121], v[76:79]
    v_mfma_f32_16x16x32_bf16 v[52:55], a[32:35], a[4:7], v[52:55]
    v_mfma_f32_4x4x4_16b_bf16 v[80:83], a[40:41], v[120:121], v[80:83]
    v_mfma_f32_4x4x4_16b_bf16 v[72:75], a[18:19], v[120:121], v[72:75]
    v_mfma_f32_16x16x32_bf16 v[56:59], a[36:39], a[0:3], v[56:59]
    v_mfma_f32_4x4x4_16b_bf16 v[76:79], a[22:23], v[120:121], v[76:79]
    v_mfma_f32_4x4x4_16b_bf16 v[80:83], a[42:43], v[120:121], v[80:83]
    v_mfma_f32_16x16x32_bf16 v[60:63], a[36:39], a[4:7], v[60:63]
    v_mfma_f32_16x16x32_bf16 v[64:67], a[40:43], a[0:3], v[64:67]
    v_mfma_f32_16x16x32_bf16 v[68:71], a[40:43], a[4:7], v[68:71]
    s_waitcnt lgkmcnt(0)
    s_barrier
    v_mfma_f32_16x16x32_bf16 v[16:19], a[44:47], a[8:11], v[16:19]
    ds_read_b128 a[0:3], v9 offset:0
    ds_read_b128 a[4:7], v9 offset:1024
    v_mfma_f32_16x16x32_bf16 v[20:23], a[44:47], a[12:15], v[20:23]
    ds_read_b64_tr_b16 a[16:17], v112 offset:0
    ds_read_b64_tr_b16 a[18:19], v112 offset:256
    v_mfma_f32_16x16x32_bf16 v[24:27], a[48:51], a[8:11], v[24:27]
    ds_read_b64_tr_b16 a[20:21], v113 offset:0
    ds_read_b64_tr_b16 a[22:23], v113 offset:256
    v_mfma_f32_16x16x32_bf16 v[28:31], a[48:51], a[12:15], v[28:31]
    ds_read_b64_tr_b16 a[24:25], v114 offset:0
    ds_read_b64_tr_b16 a[26:27], v114 offset:256
    v_mfma_f32_16x16x32_bf16 v[32:35], a[52:55], a[8:11], v[32:35]
    ds_read_b64_tr_b16 a[28:29], v115 offset:0
    ds_read_b64_tr_b16 a[30:31], v115 offset:256
    v_mfma_f32_16x16x32_bf16 v[36:39], a[52:55], a[12:15], v[36:39]
    ds_read_b64_tr_b16 a[32:33], v116 offset:0
    ds_read_b64_tr_b16 a[34:35], v116 offset:256
    v_mfma_f32_16x16x32_bf16 v[40:43], a[56:59], a[8:11], v[40:43]
    ds_read_b64_tr_b16 a[36:37], v117 offset:0
    ds_read_b64_tr_b16 a[38:39], v117 offset:256
    v_mfma_f32_16x16x32_bf16 v[44:47], a[56:59], a[12:15], v[44:47]
    ds_read_b64_tr_b16 a[40:41], v118 offset:0
    ds_read_b64_tr_b16 a[42:43], v118 offset:256
    v_mfma_f32_16x16x32_bf16 v[48:51], a[60:63], a[8:11], v[48:51]
    v_mfma_f32_4x4x4_16b_bf16 v[72:75], a[44:45], v[120:121], v[72:75]
    v_mfma_f32_4x4x4_16b_bf16 v[76:79], a[48:49], v[120:121], v[76:79]
    v_mfma_f32_16x16x32_bf16 v[52:55], a[60:63], a[12:15], v[52:55]
    v_mfma_f32_4x4x4_16b_bf16 v[80:83], a[68:69], v[120:121], v[80:83]
    v_mfma_f32_4x4x4_16b_bf16 v[72:75], a[46:47], v[120:121], v[72:75]
    v_mfma_f32_16x16x32_bf16 v[56:59], a[64:67], a[8:11], v[56:59]
    v_mfma_f32_4x4x4_16b_bf16 v[76:79], a[50:51], v[120:121], v[76:79]
    v_mfma_f32_4x4x4_16b_bf16 v[80:83], a[70:71], v[120:121], v[80:83]
    v_mfma_f32_16x16x32_bf16 v[60:63], a[64:67], a[12:15], v[60:63]
    v_mfma_f32_16x16x32_bf16 v[64:67], a[68:71], a[8:11], v[64:67]
    v_mfma_f32_16x16x32_bf16 v[68:71], a[68:71], a[12:15], v[68:71]
    s_waitcnt lgkmcnt(0)
    s_barrier
    v_mfma_f32_16x16x32_bf16 v[16:19], a[16:19], a[0:3], v[16:19]
    ds_read_b128 a[8:11], v9 offset:16384
    ds_read_b128 a[12:15], v9 offset:17408
    v_mfma_f32_16x16x32_bf16 v[20:23], a[16:19], a[4:7], v[20:23]
    ds_read_b64_tr_b16 a[44:45], v112 offset:16384
    ds_read_b64_tr_b16 a[46:47], v112 offset:16640
    v_mfma_f32_16x16x32_bf16 v[24:27], a[20:23], a[0:3], v[24:27]
    ds_read_b64_tr_b16 a[48:49], v113 offset:16384
    ds_read_b64_tr_b16 a[50:51], v113 offset:16640
    v_mfma_f32_16x16x32_bf16 v[28:31], a[20:23], a[4:7], v[28:31]
    ds_read_b64_tr_b16 a[52:53], v114 offset:16384
    ds_read_b64_tr_b16 a[54:55], v114 offset:16640
    v_mfma_f32_16x16x32_bf16 v[32:35], a[24:27], a[0:3], v[32:35]
    ds_read_b64_tr_b16 a[56:57], v115 offset:16384
    ds_read_b64_tr_b16 a[58:59], v115 offset:16640
    v_mfma_f32_16x16x32_bf16 v[36:39], a[24:27], a[4:7], v[36:39]
    ds_read_b64_tr_b16 a[60:61], v116 offset:16384
    ds_read_b64_tr_b16 a[62:63], v116 offset:16640
    v_mfma_f32_16x16x32_bf16 v[40:43], a[28:31], a[0:3], v[40:43]
    ds_read_b64_tr_b16 a[64:65], v117 offset:16384
    ds_read_b64_tr_b16 a[66:67], v117 offset:16640
    v_mfma_f32_16x16x32_bf16 v[44:47], a[28:31], a[4:7], v[44:47]
    ds_read_b64_tr_b16 a[68:69], v118 offset:16384
    ds_read_b64_tr_b16 a[70:71], v118 offset:16640
    v_mfma_f32_16x16x32_bf16 v[48:51], a[32:35], a[0:3], v[48:51]
    v_mfma_f32_4x4x4_16b_bf16 v[72:75], a[16:17], v[120:121], v[72:75]
    v_mfma_f32_4x4x4_16b_bf16 v[76:79], a[20:21], v[120:121], v[76:79]
    v_mfma_f32_16x16x32_bf16 v[52:55], a[32:35], a[4:7], v[52:55]
    v_mfma_f32_4x4x4_16b_bf16 v[80:83], a[40:41], v[120:121], v[80:83]
    v_mfma_f32_4x4x4_16b_bf16 v[72:75], a[18:19], v[120:121], v[72:75]
    v_mfma_f32_16x16x32_bf16 v[56:59], a[36:39], a[0:3], v[56:59]
    v_mfma_f32_4x4x4_16b_bf16 v[76:79], a[22:23], v[120:121], v[76:79]
    v_mfma_f32_4x4x4_16b_bf16 v[80:83], a[42:43], v[120:121], v[80:83]
    v_mfma_f32_16x16x32_bf16 v[60:63], a[36:39], a[4:7], v[60:63]
    v_mfma_f32_16x16x32_bf16 v[64:67], a[40:43], a[0:3], v[64:67]
    v_mfma_f32_16x16x32_bf16 v[68:71], a[40:43], a[4:7], v[68:71]
    s_waitcnt lgkmcnt(0)
    s_barrier
    v_mfma_f32_16x16x32_bf16 v[16:19], a[44:47], a[8:11], v[16:19]
    ds_read_b128 a[0:3], v9 offset:32768
    ds_read_b128 a[4:7], v9 offset:33792
    v_mfma_f32_16x16x32_bf16 v[20:23], a[44:47], a[12:15], v[20:23]
    ds_read_b64_tr_b16 a[16:17], v112 offset:32768
    ds_read_b64_tr_b16 a[18:19], v112 offset:33024
    v_mfma_f32_16x16x32_bf16 v[24:27], a[48:51], a[8:11], v[24:27]
    ds_read_b64_tr_b16 a[20:21], v113 offset:32768
    ds_read_b64_tr_b16 a[22:23], v113 offset:33024
    v_mfma_f32_16x16x32_bf16 v[28:31], a[48:51], a[12:15], v[28:31]
    ds_read_b64_tr_b16 a[24:25], v114 offset:32768
    ds_read_b64_tr_b16 a[26:27], v114 offset:33024
    v_mfma_f32_16x16x32_bf16 v[32:35], a[52:55], a[8:11], v[32:35]
    ds_read_b64_tr_b16 a[28:29], v115 offset:32768
    ds_read_b64_tr_b16 a[30:31], v115 offset:33024
    v_mfma_f32_16x16x32_bf16 v[36:39], a[52:55], a[12:15], v[36:39]
    ds_read_b64_tr_b16 a[32:33], v116 offset:32768
    ds_read_b64_tr_b16 a[34:35], v116 offset:33024
    v_mfma_f32_16x16x32_bf16 v[40:43], a[56:59], a[8:11], v[40:43]
    ds_read_b64_tr_b16 a[36:37], v117 offset:32768
    ds_read_b64_tr_b16 a[38:39], v117 offset:33024
    v_mfma_f32_16x16x32_bf16 v[44:47], a[56:59], a[12:15], v[44:47]
    ds_read_b64_tr_b16 a[40:41], v118 offset:32768
    ds_read_b64_tr_b16 a[42:43], v118 offset:33024
    v_mfma_f32_16x16x32_bf16 v[48:51], a[60:63], a[8:11], v[48:51]
    v_mfma_f32_4x4x4_16b_bf16 v[72:75], a[44:45], v[120:121], v[72:75]
    v_mfma_f32_4x4x4_16b_bf16 v[76:79], a[48:49], v[120:121], v[76:79]
    v_mfma_f32_16x16x32_bf16 v[52:55], a[60:63], a[12:15], v[52:55]
    v_mfma_f32_4x4x4_16b_bf16 v[80:83], a[68:69], v[120:121], v[80:83]
    v_mfma_f32_4x4x4_16b_bf16 v[72:75], a[46:47], v[120:121], v[72:75]
    v_mfma_f32_16x16x32_bf16 v[56:59], a[64:67], a[8:11], v[56:59]
    v_mfma_f32_4x4x4_16b_bf16 v[76:79], a[50:51], v[120:121], v[76:79]
    v_mfma_f32_4x4x4_16b_bf16 v[80:83], a[70:71], v[120:121], v[80:83]
    v_mfma_f32_16x16x32_bf16 v[60:63], a[64:67], a[12:15], v[60:63]
    v_mfma_f32_16x16x32_bf16 v[64:67], a[68:71], a[8:11], v[64:67]
    v_mfma_f32_16x16x32_bf16 v[68:71], a[68:71], a[12:15], v[68:71]
    s_waitcnt lgkmcnt(0)
    s_barrier
    v_mfma_f32_16x16x32_bf16 v[16:19], a[16:19], a[0:3], v[16:19]
    ds_read_b128 a[8:11], v9 offset:49152
    ds_read_b128 a[12:15], v9 offset:50176
    v_mfma_f32_16x16x32_bf16 v[20:23], a[16:19], a[4:7], v[20:23]
    ds_read_b64_tr_b16 a[44:45], v112 offset:49152
    ds_read_b64_tr_b16 a[46:47], v112 offset:49408
    v_mfma_f32_16x16x32_bf16 v[24:27], a[20:23], a[0:3], v[24:27]
    ds_read_b64_tr_b16 a[48:49], v113 offset:49152
    ds_read_b64_tr_b16 a[50:51], v113 offset:49408
    v_mfma_f32_16x16x32_bf16 v[28:31], a[20:23], a[4:7], v[28:31]
    ds_read_b64_tr_b16 a[52:53], v114 offset:49152
    ds_read_b64_tr_b16 a[54:55], v114 offset:49408
    v_mfma_f32_16x16x32_bf16 v[32:35], a[24:27], a[0:3], v[32:35]
    ds_read_b64_tr_b16 a[56:57], v115 offset:49152
    ds_read_b64_tr_b16 a[58:59], v115 offset:49408
    v_mfma_f32_16x16x32_bf16 v[36:39], a[24:27], a[4:7], v[36:39]
    ds_read_b64_tr_b16 a[60:61], v116 offset:49152
    ds_read_b64_tr_b16 a[62:63], v116 offset:49408
    v_mfma_f32_16x16x32_bf16 v[40:43], a[28:31], a[0:3], v[40:43]
    ds_read_b64_tr_b16 a[64:65], v117 offset:49152
    ds_read_b64_tr_b16 a[66:67], v117 offset:49408
    v_mfma_f32_16x16x32_bf16 v[44:47], a[28:31], a[4:7], v[44:47]
    ds_read_b64_tr_b16 a[68:69], v118 offset:49152
    ds_read_b64_tr_b16 a[70:71], v118 offset:49408
    v_mfma_f32_16x16x32_bf16 v[48:51], a[32:35], a[0:3], v[48:51]
    v_mfma_f32_4x4x4_16b_bf16 v[72:75], a[16:17], v[120:121], v[72:75]
    v_mfma_f32_4x4x4_16b_bf16 v[76:79], a[20:21], v[120:121], v[76:79]
    v_mfma_f32_16x16x32_bf16 v[52:55], a[32:35], a[4:7], v[52:55]
    v_mfma_f32_4x4x4_16b_bf16 v[80:83], a[40:41], v[120:121], v[80:83]
    v_mfma_f32_4x4x4_16b_bf16 v[72:75], a[18:19], v[120:121], v[72:75]
    v_mfma_f32_16x16x32_bf16 v[56:59], a[36:39], a[0:3], v[56:59]
    v_mfma_f32_4x4x4_16b_bf16 v[76:79], a[22:23], v[120:121], v[76:79]
    v_mfma_f32_4x4x4_16b_bf16 v[80:83], a[42:43], v[120:121], v[80:83]
    v_mfma_f32_16x16x32_bf16 v[60:63], a[36:39], a[4:7], v[60:63]
    buffer_load_dword v122, v8, s[16:19], s95 offen sc1
    buffer_load_dword v123, v8, s[16:19], s95 offen offset:128 sc1
    v_mfma_f32_16x16x32_bf16 v[64:67], a[40:43], a[0:3], v[64:67]
    s_add_u32 s4, s78, 196608
    buffer_load_dwordx4 a[80:83], v15, s[16:19], s4 offen offset:0 sc1
    buffer_load_dwordx4 a[84:87], v15, s[16:19], s4 offen offset:1024 sc1
    buffer_load_dwordx4 a[88:91], v15, s[16:19], s4 offen offset:2048 sc1
    buffer_load_dwordx4 a[92:95], v15, s[16:19], s4 offen offset:3072 sc1
    s_add_u32 s4, s78, 98304
    buffer_load_dwordx4 a[96:99], v15, s[16:19], s4 offen offset:0 sc1
    buffer_load_dwordx4 a[100:103], v15, s[16:19], s4 offen offset:1024 sc1
    buffer_load_dwordx4 a[104:107], v15, s[16:19], s4 offen offset:2048 sc1
    buffer_load_dwordx4 a[108:111], v15, s[16:19], s4 offen offset:3072 sc1
    v_mfma_f32_16x16x32_bf16 v[68:71], a[40:43], a[4:7], v[68:71]
    s_waitcnt lgkmcnt(0)
    v_mfma_f32_4x4x4_16b_bf16 v[72:75], a[44:45], v[120:121], v[72:75]
    v_mfma_f32_4x4x4_16b_bf16 v[76:79], a[48:49], v[120:121], v[76:79]
    v_mfma_f32_4x4x4_16b_bf16 v[80:83], a[68:69], v[120:121], v[80:83]
    v_mfma_f32_4x4x4_16b_bf16 v[72:75], a[46:47], v[120:121], v[72:75]
    v_mfma_f32_4x4x4_16b_bf16 v[76:79], a[50:51], v[120:121], v[76:79]
    v_mfma_f32_4x4x4_16b_bf16 v[80:83], a[70:71], v[120:121], v[80:83]
    v_mfma_f32_16x16x32_bf16 v[16:19], a[44:47], a[8:11], v[16:19]
    v_mfma_f32_16x16x32_bf16 v[20:23], a[44:47], a[12:15], v[20:23]
    v_mfma_f32_16x16x32_bf16 v[24:27], a[48:51], a[8:11], v[24:27]
    s_nop 1
    v_mov_b32 v84, v80
    v_mov_b32 v85, v81
    v_mov_b32 v86, v82
    v_mov_b32 v87, v83
    v_mfma_f32_16x16x32_bf16 v[28:31], a[48:51], a[12:15], v[28:31]
    v_permlane32_swap_b32 v72, v76
    v_permlane32_swap_b32 v73, v77
    v_permlane32_swap_b32 v74, v78
    v_permlane32_swap_b32 v75, v79
    v_mfma_f32_16x16x32_bf16 v[32:35], a[52:55], a[8:11], v[32:35]
    v_permlane32_swap_b32 v80, v84
    v_permlane32_swap_b32 v81, v85
    v_permlane32_swap_b32 v82, v86
    v_permlane32_swap_b32 v83, v87
    v_mfma_f32_16x16x32_bf16 v[36:39], a[52:55], a[12:15], v[36:39]
    v_add_f32 v72, v72, v76
    v_add_f32 v73, v73, v77
    v_add_f32 v74, v74, v78
    v_add_f32 v75, v75, v79
    v_mfma_f32_16x16x32_bf16 v[40:43], a[56:59], a[8:11], v[40:43]
    v_add_f32 v80, v80, v84
    v_add_f32 v81, v81, v85
    v_add_f32 v82, v82, v86
    v_mfma_f32_16x16x32_bf16 v[44:47], a[56:59], a[12:15], v[44:47]
    v_add_f32 v83, v83, v87
    v_permlane16_swap_b32 v72, v80
    v_permlane16_swap_b32 v73, v81
    v_mfma_f32_16x16x32_bf16 v[48:51], a[60:63], a[8:11], v[48:51]
    v_permlane16_swap_b32 v74, v82
    v_permlane16_swap_b32 v75, v83
    v_add_f32 v72, v72, v80
    v_mfma_f32_16x16x32_bf16 v[52:55], a[60:63], a[12:15], v[52:55]
    v_add_f32 v73, v73, v81
    v_add_f32 v74, v74, v82
    v_add_f32 v75, v75, v83
    ds_write_b128 v13, v[72:75]
    v_mfma_f32_16x16x32_bf16 v[56:59], a[64:67], a[8:11], v[56:59]
    v_mfma_f32_16x16x32_bf16 v[60:63], a[64:67], a[12:15], v[60:63]
    s_waitcnt lgkmcnt(0)
    s_barrier
    ds_read_b128 v[76:79], v10 offset:0
    ds_read_b128 v[80:83], v10 offset:64
    ds_read_b128 v[84:87], v11 offset:0
    ds_read_b128 v[88:91], v11 offset:64
    ds_read_b128 v[92:95], v12 offset:0
    ds_read_b128 v[96:99], v12 offset:64
    ds_read_b128 v[100:103], v14 offset:384
    v_mfma_f32_16x16x32_bf16 v[64:67], a[68:71], a[8:11], v[64:67]
    v_mfma_f32_16x16x32_bf16 v[68:71], a[68:71], a[12:15], v[68:71]
    s_waitcnt vmcnt(8) lgkmcnt(0)
    v_pk_fma_f32 v[16:17], v[76:77], v[122:123], v[16:17] op_sel:[0,0,0] op_sel_hi:[1,0,1]
    v_pk_fma_f32 v[18:19], v[78:79], v[122:123], v[18:19] op_sel:[0,0,0] op_sel_hi:[1,0,1]
    v_pk_fma_f32 v[24:25], v[80:81], v[122:123], v[24:25] op_sel:[0,0,0] op_sel_hi:[1,0,1]
    v_pk_fma_f32 v[26:27], v[82:83], v[122:123], v[26:27] op_sel:[0,0,0] op_sel_hi:[1,0,1]
    v_cvt_pk_bf16_f32 v104, v16, v17
    v_cvt_pk_bf16_f32 v105, v18, v19
    v_cvt_pk_bf16_f32 v106, v24, v25
    v_cvt_pk_bf16_f32 v107, v26, v27
    v_pk_max_i16 v104, v104, 0
    v_pk_max_i16 v105, v105, 0
    v_pk_max_i16 v106, v106, 0
    v_pk_max_i16 v107, v107, 0
    buffer_store_dwordx4 v[104:107], v15, s[16:19], s74 offen sc1
    v_pk_fma_f32 v[20:21], v[76:77], v[122:123], v[20:21] op_sel:[0,1,0] op_sel_hi:[1,1,1]
    v_pk_fma_f32 v[22:23], v[78:79], v[122:123], v[22:23] op_sel:[0,1,0] op_sel_hi:[1,1,1]
    v_pk_fma_f32 v[28:29], v[80:81], v[122:123], v[28:29] op_sel:[0,1,0] op_sel_hi:[1,1,1]
    v_pk_fma_f32 v[30:31], v[82:83], v[122:123], v[30:31] op_sel:[0,1,0] op_sel_hi:[1,1,1]
    v_cvt_pk_bf16_f32 v108, v20, v21
    v_cvt_pk_bf16_f32 v109, v22, v23
    v_cvt_pk_bf16_f32 v110, v28, v29
    v_cvt_pk_bf16_f32 v111, v30, v31
    v_pk_max_i16 v108, v108, 0
    v_pk_max_i16 v109, v109, 0
    v_pk_max_i16 v110, v110, 0
    v_pk_max_i16 v111, v111, 0
    buffer_store_dwordx4 v[108:111], v15, s[16:19], s70 offen sc1
    v_pk_fma_f32 v[32:33], v[84:85], v[122:123], v[32:33] op_sel:[0,0,0] op_sel_hi:[1,0,1]
    v_pk_fma_f32 v[34:35], v[86:87], v[122:123], v[34:35] op_sel:[0,0,0] op_sel_hi:[1,0,1]
    v_pk_fma_f32 v[40:41], v[88:89], v[122:123], v[40:41] op_sel:[0,0,0] op_sel_hi:[1,0,1]
    v_pk_fma_f32 v[42:43], v[90:91], v[122:123], v[42:43] op_sel:[0,0,0] op_sel_hi:[1,0,1]
    v_cvt_pk_bf16_f32 v104, v32, v33
    v_cvt_pk_bf16_f32 v105, v34, v35
    v_cvt_pk_bf16_f32 v106, v40, v41
    v_cvt_pk_bf16_f32 v107, v42, v43
    v_pk_max_i16 v104, v104, 0
    v_pk_max_i16 v105, v105, 0
    v_pk_max_i16 v106, v106, 0
    v_pk_max_i16 v107, v107, 0
    buffer_store_dwordx4 v[104:107], v15, s[16:19], s75 offen sc1
    v_pk_fma_f32 v[36:37], v[84:85], v[122:123], v[36:37] op_sel:[0,1,0] op_sel_hi:[1,1,1]
    v_pk_fma_f32 v[38:39], v[86:87], v[122:123], v[38:39] op_sel:[0,1,0] op_sel_hi:[1,1,1]
    v_pk_fma_f32 v[44:45], v[88:89], v[122:123], v[44:45] op_sel:[0,1,0] op_sel_hi:[1,1,1]
    v_pk_fma_f32 v[46:47], v[90:91], v[122:123], v[46:47] op_sel:[0,1,0] op_sel_hi:[1,1,1]
    v_cvt_pk_bf16_f32 v108, v36, v37
    v_cvt_pk_bf16_f32 v109, v38, v39
    v_cvt_pk_bf16_f32 v110, v44, v45
    v_cvt_pk_bf16_f32 v111, v46, v47
    v_pk_max_i16 v108, v108, 0
    v_pk_max_i16 v109, v109, 0
    v_pk_max_i16 v110, v110, 0
    v_pk_max_i16 v111, v111, 0
    buffer_store_dwordx4 v[108:111], v15, s[16:19], s71 offen sc1
    v_pk_fma_f32 v[48:49], v[92:93], v[122:123], v[48:49] op_sel:[0,0,0] op_sel_hi:[1,0,1]
    v_pk_fma_f32 v[50:51], v[94:95], v[122:123], v[50:51] op_sel:[0,0,0] op_sel_hi:[1,0,1]
    v_pk_fma_f32 v[56:57], v[96:97], v[122:123], v[56:57] op_sel:[0,0,0] op_sel_hi:[1,0,1]
    v_pk_fma_f32 v[58:59], v[98:99], v[122:123], v[58:59] op_sel:[0,0,0] op_sel_hi:[1,0,1]
    v_cvt_pk_bf16_f32 v104, v48, v49
    v_cvt_pk_bf16_f32 v105, v50, v51
    v_cvt_pk_bf16_f32 v106, v56, v57
    v_cvt_pk_bf16_f32 v107, v58, v59
    v_pk_max_i16 v104, v104, 0
    v_pk_max_i16 v105, v105, 0
    v_pk_max_i16 v106, v106, 0
    v_pk_max_i16 v107, v107, 0
    buffer_store_dwordx4 v[104:107], v15, s[16:19], s76 offen sc1
    v_pk_fma_f32 v[52:53], v[92:93], v[122:123], v[52:53] op_sel:[0,1,0] op_sel_hi:[1,1,1]
    v_pk_fma_f32 v[54:55], v[94:95], v[122:123], v[54:55] op_sel:[0,1,0] op_sel_hi:[1,1,1]
    v_pk_fma_f32 v[60:61], v[96:97], v[122:123], v[60:61] op_sel:[0,1,0] op_sel_hi:[1,1,1]
    v_pk_fma_f32 v[62:63], v[98:99], v[122:123], v[62:63] op_sel:[0,1,0] op_sel_hi:[1,1,1]
    v_cvt_pk_bf16_f32 v108, v52, v53
    v_cvt_pk_bf16_f32 v109, v54, v55
    v_cvt_pk_bf16_f32 v110, v60, v61
    v_cvt_pk_bf16_f32 v111, v62, v63
    v_pk_max_i16 v108, v108, 0
    v_pk_max_i16 v109, v109, 0
    v_pk_max_i16 v110, v110, 0
    v_pk_max_i16 v111, v111, 0
    buffer_store_dwordx4 v[108:111], v15, s[16:19], s72 offen sc1
    v_pk_fma_f32 v[64:65], v[100:101], v[122:123], v[64:65] op_sel:[0,0,0] op_sel_hi:[1,0,1]
    v_pk_fma_f32 v[66:67], v[102:103], v[122:123], v[66:67] op_sel:[0,0,0] op_sel_hi:[1,0,1]
    v_pk_fma_f32 v[68:69], v[100:101], v[122:123], v[68:69] op_sel:[0,1,0] op_sel_hi:[1,1,1]
    v_pk_fma_f32 v[70:71], v[102:103], v[122:123], v[70:71] op_sel:[0,1,0] op_sel_hi:[1,1,1]
    v_cvt_pk_bf16_f32 v104, v64, v65
    v_cvt_pk_bf16_f32 v105, v66, v67
    v_cvt_pk_bf16_f32 v106, v68, v69
    v_cvt_pk_bf16_f32 v107, v70, v71
    v_pk_max_i16 v104, v104, 0
    v_pk_max_i16 v105, v105, 0
    v_pk_max_i16 v106, v106, 0
    v_pk_max_i16 v107, v107, 0
    buffer_store_dwordx4 v[104:107], v15, s[16:19], s77 offen sc1
    s_barrier
    s_lshl_b32 s4, s86, 6
    s_add_u32 s4, s4, 134
    v_add_u32 v16, s4, v0
    v_lshrrev_b32 v17, 3, v16
    v_add_u32 v17, v17, v16
    v_xor_b32 v18, s84, v16
    v_and_b32 v18, 1, v18
    v_lshl_add_u32 v17, v17, 1, v18
    v_lshlrev_b32 v17, 4, v17
    v_add_u32 v20, 132608, v17
    ds_read_b64 v[24:25], v20 offset:8
    v_add_u32 v16, 1, v16
    v_lshrrev_b32 v17, 3, v16
    v_add_u32 v17, v17, v16
    v_xor_b32 v18, s84, v16
    v_and_b32 v18, 1, v18
    v_lshl_add_u32 v17, v17, 1, v18
    v_lshlrev_b32 v17, 4, v17
    v_add_u32 v21, 132608, v17
    ds_read_b128 v[28:31], v21
    v_add_u32 v16, 1, v16
    v_lshrrev_b32 v17, 3, v16
    v_add_u32 v17, v17, v16
    v_xor_b32 v18, s84, v16
    v_and_b32 v18, 1, v18
    v_lshl_add_u32 v17, v17, 1, v18
    v_lshlrev_b32 v17, 4, v17
    v_add_u32 v22, 132608, v17
    ds_read_b64 v[26:27], v22
    s_mul_i32 s4, s84, 4112
    s_lshl_b32 s5, s86, 2
    s_sub_u32 s4, s4, s5
    s_add_u32 s4, s4, 149280
    v_lshlrev_b32 v17, 3, v4
    v_lshlrev_b32 v18, 5, v3
    v_sub_u32 v17, v17, v18
    v_add_u32 v17, s4, v17
    ds_read_b32 v64, v17 offset:24
    ds_read_b32 v65, v17 offset:16
    ds_read_b32 v66, v17 offset:8
    ds_read_b32 v67, v17 offset:0
    s_lshl_b32 s4, s84, 11
    s_lshl_b32 s5, s86, 10
    s_add_u32 s4, s4, s5
    s_add_u32 s4, s4, 94464
    v_lshlrev_b32 v18, 8, v4
    v_lshl_add_u32 v18, v3, 3, v18
    v_add_u32 v18, s4, v18
    s_mul_i32 s4, s84, 4352
    s_add_u32 s4, s4, 85760
    v_mov_b32 v23, s4
    s_add_u32 s4, s4, s5
    v_add_u32 v19, s4, v15
    v_mov_b32 v68, 0
    v_mov_b32 v69, 0
    v_mov_b32 v70, 0
    v_mov_b32 v71, 0
    ds_write_b128 v23, v[68:71]
    ds_write_b64 v18, v[68:69] offset:128
    s_waitcnt lgkmcnt(6)
    v_lshlrev_b32 v32, 16, v24
    v_and_b32 v33, 0xffff0000, v24
    v_lshlrev_b32 v34, 16, v25
    v_and_b32 v35, 0xffff0000, v25
    v_lshlrev_b32 v36, 16, v28
    v_and_b32 v37, 0xffff0000, v28
    v_lshlrev_b32 v38, 16, v29
    v_and_b32 v39, 0xffff0000, v29
    v_lshlrev_b32 v40, 16, v30
    v_and_b32 v41, 0xffff0000, v30
    v_lshlrev_b32 v42, 16, v31
    v_and_b32 v43, 0xffff0000, v31
    v_lshlrev_b32 v44, 16, v26
    v_and_b32 v45, 0xffff0000, v26
    v_lshlrev_b32 v46, 16, v27
    v_and_b32 v47, 0xffff0000, v27
    v_add_f32 v16, v33, v34
    v_add_f32 v17, v35, v36
    v_add_f32 v20, v37, v38
    v_add_f32 v16, v16, v17
    v_add_f32 v20, v20, v39
    v_add_f32 v48, v16, v20
    v_add_f32 v56, v32, v40
    v_sub_f32 v16, v40, v33
    v_add_f32 v56, v56, v48
    v_add_f32 v49, v48, v16
    v_add_f32 v57, v33, v41
    v_sub_f32 v17, v41, v34
    v_add_f32 v57, v57, v49
    v_add_f32 v50, v49, v17
    v_add_f32 v58, v34, v42
    v_sub_f32 v16, v42, v35
    v_add_f32 v58, v58, v50
    v_add_f32 v51, v50, v16
    v_add_f32 v59, v35, v43
    v_sub_f32 v17, v43, v36
    v_add_f32 v59, v59, v51
    v_add_f32 v52, v51, v17
    v_add_f32 v60, v36, v44
    v_sub_f32 v16, v44, v37
    v_add_f32 v60, v60, v52
    v_add_f32 v53, v52, v16
    v_add_f32 v61, v37, v45
    v_sub_f32 v17, v45, v38
    v_add_f32 v61, v61, v53
    v_add_f32 v54, v53, v17
    v_add_f32 v62, v38, v46
    v_sub_f32 v16, v46, v39
    v_add_f32 v62, v62, v54
    v_add_f32 v55, v54, v16
    v_add_f32 v63, v39, v47
    v_add_f32 v63, v63, v55
    s_waitcnt lgkmcnt(2)
    v_writelane_b32 v65, 0, 15
    v_writelane_b32 v66, 0, 15
    v_writelane_b32 v66, 0, 31
    v_writelane_b32 v67, 0, 15
    v_writelane_b32 v67, 0, 31
    v_writelane_b32 v67, 0, 47
    v_cvt_pk_bf16_f32 v24, v48, v49
    v_cvt_pk_bf16_f32 v28, v56, v57
    v_cvt_pk_bf16_f32 v25, v50, v51
    v_cvt_pk_bf16_f32 v29, v58, v59
    v_cvt_pk_bf16_f32 v26, v52, v53
    v_cvt_pk_bf16_f32 v30, v60, v61
    v_cvt_pk_bf16_f32 v27, v54, v55
    v_cvt_pk_bf16_f32 v31, v62, v63
    v_cvt_pk_bf16_f32 v64, v64, v65
    v_cvt_pk_bf16_f32 v65, v66, v67
    ds_write_b128 v19, v[24:27] offset:2176
    ds_write_b128 v19, v[28:31] offset:16
    ds_write_b64 v18, v[64:65]
    s_waitcnt vmcnt(0)
    v_mov_b32 v125, 0
    v_mov_b32 v126, s41
    s_mov_b64 exec, 1
    buffer_store_dword v126, v125, s[16:19], s93 offen sc1
    s_mov_b64 exec, -1
    s_waitcnt lgkmcnt(0)
    s_barrier
    s_lshl_b32 s6, s33, 14
    s_add_u32 s4, s78, 425984
    s_add_u32 m0, s6, 8192
    s_nop 0
    buffer_load_dwordx4 v15, s[16:19], s4 offen offset:0 sc1 lds
    buffer_load_dwordx4 v15, s[16:19], s4 offen offset:1024 sc1 lds
    buffer_load_dwordx4 v15, s[16:19], s4 offen offset:2048 sc1 lds
    buffer_load_dwordx4 v15, s[16:19], s4 offen offset:3072 sc1 lds
    s_lshl_b32 s6, s33, 14
    s_add_u32 s4, s78, 327680
    s_add_u32 m0, s6, 12288
    s_nop 0
    buffer_load_dwordx4 v15, s[16:19], s4 offen offset:0 sc1 lds
    buffer_load_dwordx4 v15, s[16:19], s4 offen offset:1024 sc1 lds
    buffer_load_dwordx4 v15, s[16:19], s4 offen offset:2048 sc1 lds
    buffer_load_dwordx4 v15, s[16:19], s4 offen offset:3072 sc1 lds
    s_add_u32 s4, s78, 0
    buffer_load_dwordx4 a[0:3], v15, s[16:19], s4 offen offset:0 sc1
    buffer_load_dwordx4 a[4:7], v15, s[16:19], s4 offen offset:1024 sc1
    buffer_load_dwordx4 a[8:11], v15, s[16:19], s4 offen offset:2048 sc1
    buffer_load_dwordx4 a[12:15], v15, s[16:19], s4 offen offset:3072 sc1
    s_add_u32 s4, s78, 32768
    buffer_load_dwordx4 a[16:19], v15, s[16:19], s4 offen offset:0 sc1
    buffer_load_dwordx4 a[20:23], v15, s[16:19], s4 offen offset:1024 sc1
    buffer_load_dwordx4 a[24:27], v15, s[16:19], s4 offen offset:2048 sc1
    buffer_load_dwordx4 a[28:31], v15, s[16:19], s4 offen offset:3072 sc1
    s_add_u32 s4, s78, 65536
    buffer_load_dwordx4 a[32:35], v15, s[16:19], s4 offen offset:0 sc1
    buffer_load_dwordx4 a[36:39], v15, s[16:19], s4 offen offset:1024 sc1
    buffer_load_dwordx4 a[40:43], v15, s[16:19], s4 offen offset:2048 sc1
    buffer_load_dwordx4 a[44:47], v15, s[16:19], s4 offen offset:3072 sc1
    s_mul_i32 s5, s39, 224
    s_mul_i32 s4, s33, 14
    s_add_u32 s5, s5, s4
    s_lshl_b32 s5, s5, 10
    s_add_u32 s5, s5, 4194304
    s_xor_b32 s4, s33, 3
    s_mul_i32 s4, s4, 57344
    s_add_u32 s70, s4, s5
    s_xor_b32 s4, s33, 2
    s_mul_i32 s4, s4, 57344
    s_add_u32 s71, s4, s5
    s_xor_b32 s4, s33, 1
    s_mul_i32 s4, s4, 57344
    s_add_u32 s72, s4, s5
    s_xor_b32 s4, s33, 0
    s_mul_i32 s4, s4, 57344
    s_add_u32 s73, s4, s5
    s_lshl_b32 s4, s39, 15
    s_add_u32 s4, s4, s7
    s_add_u32 s4, s4, 16777216
    s_lshl_b32 s5, s84, 14
    s_add_u32 s46, s4, s5
    s_xor_b32 s5, s5, 0x4000
    s_add_u32 s44, s4, s5
    s_lshl_b32 s4, s86, 10
    s_add_u32 s45, s44, s4
    s_add_u32 s47, s46, s4
    s_xor_b32 s4, s4, 0x400
    s_add_u32 s44, s44, s4
    s_add_u32 s46, s46, s4
    s_lshl_b32 s4, s33, 11
    s_add_u32 s91, s4, 65536
    s_lshl_b32 s5, s39, 10
    s_add_u32 s82, s5, 12713984
    s_lshl_b32 s5, s39, 7
    s_lshr_b32 s4, s39, 4
    s_lshl3_add_u32 s4, s4, s40
    s_lshl_b32 s4, s4, 11
    s_add_u32 s83, s4, 12845056
    s_lshl_b32 s4, s40, 18
    s_add_u32 s4, s4, s5
    s_lshl_b32 s5, s33, 16
    s_add_u32 s4, s4, s5
    s_add_u32 s81, s4, 2097152
    s_lshl2_add_u32 s4, s39, s33
    s_lshl_b32 s4, s4, 7
    s_add_u32 s89, s4, 12582916
    v_and_b32 v9, 31, v0
    v_lshlrev_b32 v9, 5, v9
    buffer_load_dword v125, v9, s[16:19], s82 offen sc1
    s_add_u32 s4, s78, 131072
    buffer_load_dwordx4 a[48:51], v15, s[16:19], s4 offen offset:0 sc1
    buffer_load_dwordx4 a[52:55], v15, s[16:19], s4 offen offset:1024 sc1
    buffer_load_dwordx4 a[56:59], v15, s[16:19], s4 offen offset:2048 sc1
    buffer_load_dwordx4 a[60:63], v15, s[16:19], s4 offen offset:3072 sc1
    s_add_u32 s4, s78, 163840
    buffer_load_dwordx4 a[64:67], v15, s[16:19], s4 offen offset:0 sc1
    buffer_load_dwordx4 a[68:71], v15, s[16:19], s4 offen offset:1024 sc1
    buffer_load_dwordx4 a[72:75], v15, s[16:19], s4 offen offset:2048 sc1
    buffer_load_dwordx4 a[76:79], v15, s[16:19], s4 offen offset:3072 sc1
    s_lshl_b32 s4, s33, 13
    s_add_u32 s4, s4, 99840
    v_add_u32 v5, s4, v15
    s_xor_b32 s4, s33, 1
    s_lshl_b32 s4, s4, 13
    s_add_u32 s4, s4, 99840
    v_add_u32 v6, s4, v15
    s_xor_b32 s4, s33, 3
    s_lshl_b32 s4, s4, 13
    s_add_u32 s4, s4, 99840
    v_add_u32 v8, s4, v15
    s_lshl_b32 s4, s33, 14
    v_add_u32 v126, s4, v15
    v_add_u32 v7, 10240, v126
    v_add_u32 v10, 8192, v126
    v_lshrrev_b32 v11, 2, v3
    v_lshl_add_u32 v11, v4, 4, v11
    v_lshlrev_b32 v11, 7, v11
    v_and_b32 v126, 3, v3
    v_lshl_add_u32 v11, v126, 3, v11
    s_lshl_b32 s4, s33, 5
    s_add_u32 s4, s4, 65536
    v_add_u32 v11, s4, v11
    v_lshlrev_b32 v13, 7, v3
    v_lshl_add_u32 v13, v4, 5, v13
    s_lshl_b32 s4, s33, 11
    s_add_u32 s4, s4, 73728
    v_add_u32 v13, s4, v13
    s_lshl_b32 s4, s39, 16
    s_lshl_b32 s5, s40, 7
    s_add_u32 s6, s4, s5
    s_lshl_b32 s5, s33, 14
    s_add_u32 s4, s6, s5
    s_add_u32 s4, s4, 0
    v_lshlrev_b32 v12, 10, v3
    v_lshl_add_u32 v12, v4, 5, v12
    v_add_u32 v12, s4, v12
    s_lshl_b32 s5, s33, 14
    s_add_u32 s59, s6, s5
    v_lshrrev_b32 v1, 3, v0
    v_and_b32 v126, 7, v0
    v_lshlrev_b32 v126, 4, v126
    v_lshl_add_u32 v2, v1, 10, v126
    v_lshl_add_u32 v1, v1, 12, v126
    s_barrier
    s_waitcnt vmcnt(8)
    v_cmp_ne_u32 vcc, s41, v125
    s_nop 0
    s_cmp_eq_u64 vcc, 0
    s_cbranch_scc1 L_ok6
    s_mov_b32 s96, 0
    buffer_load_dword v124, v9, s[16:19], s82 offen sc1
    s_sleep 6
L_chk6:
    buffer_load_dword v125, v9, s[16:19], s82 offen sc1
    s_waitcnt vmcnt(1)
    v_cmp_ne_u32 vcc, s41, v124
    s_nop 0
    s_cmp_eq_u64 vcc, 0
    s_cbranch_scc1 L_ok6
    buffer_load_dword v124, v9, s[16:19], s82 offen sc1
    s_waitcnt vmcnt(1)
    v_cmp_ne_u32 vcc, s41, v125
    s_nop 0
    s_cmp_eq_u64 vcc, 0
    s_cbranch_scc1 L_ok6
    s_add_u32 s96, s96, 1
    s_cmp_lt_u32 s96, 0x20000
    s_cbranch_scc1 L_chk6
L_ok6:
    s_barrier
    s_add_u32 s4, s70, 0
    buffer_load_dwordx4 v[16:19], v15, s[16:19], s4 offen offset:0 sc1
    buffer_load_dwordx4 v[20:23], v15, s[16:19], s4 offen offset:1024 sc1
    buffer_load_dwordx4 v[24:27], v15, s[16:19], s4 offen offset:2048 sc1
    s_add_u32 s4, s70, 4096
    buffer_load_dwordx4 v[28:31], v15, s[16:19], s4 offen offset:0 sc1
    buffer_load_dwordx4 v[32:35], v15, s[16:19], s4 offen offset:1024 sc1
    buffer_load_dwordx4 v[36:39], v15, s[16:19], s4 offen offset:2048 sc1
    buffer_load_dwordx4 v[72:75], v15, s[16:19], s44 offen sc1
    buffer_load_dwordx4 v[76:79], v15, s[16:19], s45 offen sc1
    v_lshlrev_b32 v9, 5, v0
    s_waitcnt vmcnt(7)
    v_mfma_f32_16x16x32_bf16 v[56:59], a[0:3], v[16:19], 0
    v_mfma_f32_16x16x32_bf16 v[60:63], a[4:7], v[16:19], 0
    s_add_u32 s4, s71, 0
    buffer_load_dwordx4 v[40:43], v15, s[16:19], s4 offen offset:0 sc1
    v_mfma_f32_16x16x32_bf16 v[64:67], a[8:11], v[16:19], 0
    v_mfma_f32_16x16x32_bf16 v[68:71], a[12:15], v[16:19], 0
    buffer_load_dwordx4 v[44:47], v15, s[16:19], s4 offen offset:1024 sc1
    s_waitcnt vmcnt(8)
    v_mfma_f32_16x16x32_bf16 v[56:59], a[16:19], v[20:23], v[56:59]
    v_mfma_f32_16x16x32_bf16 v[60:63], a[20:23], v[20:23], v[60:63]
    buffer_load_dwordx4 a[112:115], v15, s[16:19], s4 offen offset:2048 sc1
    v_mfma_f32_16x16x32_bf16 v[64:67], a[24:27], v[20:23], v[64:67]
    v_mfma_f32_16x16x32_bf16 v[68:71], a[28:31], v[20:23], v[68:71]
    s_add_u32 s4, s71, 4096
    buffer_load_dwordx4 a[116:119], v15, s[16:19], s4 offen offset:0 sc1
    s_waitcnt vmcnt(9)
    v_mfma_f32_16x16x32_bf16 v[56:59], a[32:35], v[24:27], v[56:59]
    v_mfma_f32_16x16x32_bf16 v[60:63], a[36:39], v[24:27], v[60:63]
    buffer_load_dwordx4 a[120:123], v15, s[16:19], s4 offen offset:1024 sc1
    v_mfma_f32_16x16x32_bf16 v[64:67], a[40:43], v[24:27], v[64:67]
    v_mfma_f32_16x16x32_bf16 v[68:71], a[44:47], v[24:27], v[68:71]
    buffer_load_dwordx4 a[124:127], v15, s[16:19], s4 offen offset:2048 sc1
    s_waitcnt vmcnt(10)
    v_mfma_f32_16x16x32_bf16 v[56:59], a[48:51], v[28:31], v[56:59]
    v_mfma_f32_16x16x32_bf16 v[60:63], a[52:55], v[28:31], v[60:63]
    v_mfma_f32_16x16x32_bf16 v[64:67], a[56:59], v[28:31], v[64:67]
    v_mfma_f32_16x16x32_bf16 v[68:71], a[60:63], v[28:31], v[68:71]
    s_waitcnt vmcnt(9)
    v_mfma_f32_16x16x32_bf16 v[56:59], a[64:67], v[32:35], v[56:59]
    v_mfma_f32_16x16x32_bf16 v[60:63], a[68:71], v[32:35], v[60:63]
    v_mfma_f32_16x16x32_bf16 v[64:67], a[72:75], v[32:35], v[64:67]
    v_mfma_f32_16x16x32_bf16 v[68:71], a[76:79], v[32:35], v[68:71]
    s_waitcnt vmcnt(8)
    v_mfma_f32_16x16x32_bf16 v[56:59], a[80:83], v[36:39], v[56:59]
    v_mfma_f32_16x16x32_bf16 v[60:63], a[84:87], v[36:39], v[60:63]
    s_waitcnt vmcnt(6)
    s_cmp_eq_u32 s86, 1
    s_cbranch_scc1 L_sw7
    v_swap_b32 v72, v78
    v_swap_b32 v73, v79
    s_branch L_sx7
L_sw7:
    v_swap_b32 v74, v76
    v_swap_b32 v75, v77
L_sx7:
    v_mfma_f32_16x16x32_bf16 v[64:67], a[88:91], v[36:39], v[64:67]
    v_mfma_f32_16x16x32_bf16 v[68:71], a[92:95], v[36:39], v[68:71]
    v_mfma_f32_16x16x32_bf16 v[56:59], a[96:99], v[72:75], v[56:59]
    v_mfma_f32_16x16x32_bf16 v[60:63], a[100:103], v[72:75], v[60:63]
    v_mfma_f32_16x16x32_bf16 v[64:67], a[104:107], v[72:75], v[64:67]
    v_mfma_f32_16x16x32_bf16 v[68:71], a[108:111], v[72:75], v[68:71]
    s_nop 4
    ds_write_b128 v5, v[56:59] offset:0
    ds_write_b128 v5, v[60:63] offset:1024
    ds_write_b128 v5, v[64:67] offset:2048
    ds_write_b128 v5, v[68:71] offset:3072
    s_add_u32 s4, s72, 0
    buffer_load_dwordx4 v[16:19], v15, s[16:19], s4 offen offset:0 sc1
    s_waitcnt lgkmcnt(0)
    s_barrier
    ds_read_b128 v[56:59], v6 offset:0
    ds_read_b128 v[60:63], v6 offset:1024
    ds_read_b128 v[64:67], v6 offset:2048
    ds_read_b128 v[68:71], v6 offset:3072
    buffer_load_dwordx4 v[20:23], v15, s[16:19], s4 offen offset:1024 sc1
    buffer_load_dwordx4 v[24:27], v15, s[16:19], s4 offen offset:2048 sc1
    s_add_u32 s4, s72, 4096
    buffer_load_dwordx4 v[28:31], v15, s[16:19], s4 offen offset:0 sc1
    buffer_load_dwordx4 v[32:35], v15, s[16:19], s4 offen offset:1024 sc1
    buffer_load_dwordx4 v[36:39], v15, s[16:19], s4 offen offset:2048 sc1
    buffer_load_dwordx4 v[80:83], v15, s[16:19], s46 offen sc1
    buffer_load_dwordx4 v[84:87], v15, s[16:19], s47 offen sc1
    s_waitcnt lgkmcnt(0)
    s_waitcnt vmcnt(13)
    v_mfma_f32_16x16x32_bf16 v[56:59], a[0:3], v[40:43], v[56:59]
    v_mfma_f32_16x16x32_bf16 v[60:63], a[4:7], v[40:43], v[60:63]
    v_mfma_f32_16x16x32_bf16 v[64:67], a[8:11], v[40:43], v[64:67]
    v_mfma_f32_16x16x32_bf16 v[68:71], a[12:15], v[40:43], v[68:71]
    s_waitcnt vmcnt(12)
    v_mfma_f32_16x16x32_bf16 v[56:59], a[16:19], v[44:47], v[56:59]
    v_mfma_f32_16x16x32_bf16 v[60:63], a[20:23], v[44:47], v[60:63]
    v_mfma_f32_16x16x32_bf16 v[64:67], a[24:27], v[44:47], v[64:67]
    v_mfma_f32_16x16x32_bf16 v[68:71], a[28:31], v[44:47], v[68:71]
    s_waitcnt vmcnt(11)
    v_mfma_f32_16x16x32_bf16 v[56:59], a[32:35], a[112:115], v[56:59]
    v_mfma_f32_16x16x32_bf16 v[60:63], a[36:39], a[112:115], v[60:63]
    v_mfma_f32_16x16x32_bf16 v[64:67], a[40:43], a[112:115], v[64:67]
    v_mfma_f32_16x16x32_bf16 v[68:71], a[44:47], a[112:115], v[68:71]
    s_waitcnt vmcnt(10)
    v_mfma_f32_16x16x32_bf16 v[56:59], a[48:51], a[116:119], v[56:59]
    v_mfma_f32_16x16x32_bf16 v[60:63], a[52:55], a[116:119], v[60:63]
    v_mfma_f32_16x16x32_bf16 v[64:67], a[56:59], a[116:119], v[64:67]
    v_mfma_f32_16x16x32_bf16 v[68:71], a[60:63], a[116:119], v[68:71]
    s_waitcnt vmcnt(9)
    v_mfma_f32_16x16x32_bf16 v[56:59], a[64:67], a[120:123], v[56:59]
    s_barrier
    v_mfma_f32_16x16x32_bf16 v[60:63], a[68:71], a[120:123], v[60:63]
    v_mfma_f32_16x16x32_bf16 v[64:67], a[72:75], a[120:123], v[64:67]
    v_mfma_f32_16x16x32_bf16 v[68:71], a[76:79], a[120:123], v[68:71]
    s_waitcnt vmcnt(8)
    v_mfma_f32_16x16x32_bf16 v[56:59], a[80:83], a[124:127], v[56:59]
    v_mfma_f32_16x16x32_bf16 v[60:63], a[84:87], a[124:127], v[60:63]
    v_mfma_f32_16x16x32_bf16 v[64:67], a[88:91], a[124:127], v[64:67]
    v_mfma_f32_16x16x32_bf16 v[68:71], a[92:95], a[124:127], v[68:71]
    v_mfma_f32_16x16x32_bf16 v[56:59], a[96:99], v[76:79], v[56:59]
    v_mfma_f32_16x16x32_bf16 v[60:63], a[100:103], v[76:79], v[60:63]
    v_mfma_f32_16x16x32_bf16 v[64:67], a[104:107], v[76:79], v[64:67]
    v_mfma_f32_16x16x32_bf16 v[68:71], a[108:111], v[76:79], v[68:71]
    s_nop 4
    ds_write_b128 v5, v[56:59] offset:4096
    ds_write_b128 v5, v[60:63] offset:5120
    ds_write_b128 v5, v[64:67] offset:6144
    ds_write_b128 v5, v[68:71] offset:7168
    s_add_u32 s4, s73, 0
    buffer_load_dwordx4 v[40:43], v15, s[16:19], s4 offen offset:0 sc1
    s_waitcnt lgkmcnt(0)
    s_barrier
    ds_read_b128 v[56:59], v8 offset:4096
    ds_read_b128 v[60:63], v8 offset:5120
    ds_read_b128 v[64:67], v8 offset:6144
    ds_read_b128 v[68:71], v8 offset:7168
    buffer_load_dwordx4 v[44:47], v15, s[16:19], s4 offen offset:1024 sc1
    buffer_load_dwordx4 a[112:115], v15, s[16:19], s4 offen offset:2048 sc1
    s_add_u32 s4, s73, 4096
    buffer_load_dwordx4 a[116:119], v15, s[16:19], s4 offen offset:0 sc1
    buffer_load_dwordx4 a[120:123], v15, s[16:19], s4 offen offset:1024 sc1
    buffer_load_dwordx4 a[124:127], v15, s[16:19], s4 offen offset:2048 sc1
    s_add_u32 m0, s91, 8192
    s_add_u32 s5, s59, 7168
    buffer_load_dwordx4 v2, s[8:11], s59 offen lds
    buffer_load_dwordx4 v2, s[8:11], s5 offen offset:1024 lds
    v_lshlrev_b32 v126, 3, v3
    buffer_load_dword v14, v126, s[16:19], s89 offen sc1
    s_waitcnt lgkmcnt(0)
    s_waitcnt vmcnt(16)
    v_mfma_f32_16x16x32_bf16 v[56:59], a[0:3], v[16:19], v[56:59]
    v_mfma_f32_16x16x32_bf16 v[60:63], a[4:7], v[16:19], v[60:63]
    v_mfma_f32_16x16x32_bf16 v[64:67], a[8:11], v[16:19], v[64:67]
    v_mfma_f32_16x16x32_bf16 v[68:71], a[12:15], v[16:19], v[68:71]
    s_waitcnt vmcnt(15)
    v_mfma_f32_16x16x32_bf16 v[56:59], a[16:19], v[20:23], v[56:59]
    v_mfma_f32_16x16x32_bf16 v[60:63], a[20:23], v[20:23], v[60:63]
    v_mfma_f32_16x16x32_bf16 v[64:67], a[24:27], v[20:23], v[64:67]
    v_mfma_f32_16x16x32_bf16 v[68:71], a[28:31], v[20:23], v[68:71]
    s_waitcnt vmcnt(14)
    v_mfma_f32_16x16x32_bf16 v[56:59], a[32:35], v[24:27], v[56:59]
    v_mfma_f32_16x16x32_bf16 v[60:63], a[36:39], v[24:27], v[60:63]
    v_mfma_f32_16x16x32_bf16 v[64:67], a[40:43], v[24:27], v[64:67]
    v_mfma_f32_16x16x32_bf16 v[68:71], a[44:47], v[24:27], v[68:71]
    s_waitcnt vmcnt(13)
    v_mfma_f32_16x16x32_bf16 v[56:59], a[48:51], v[28:31], v[56:59]
    v_mfma_f32_16x16x32_bf16 v[60:63], a[52:55], v[28:31], v[60:63]
    v_mfma_f32_16x16x32_bf16 v[64:67], a[56:59], v[28:31], v[64:67]
    v_mfma_f32_16x16x32_bf16 v[68:71], a[60:63], v[28:31], v[68:71]
    s_waitcnt vmcnt(12)
    v_mfma_f32_16x16x32_bf16 v[56:59], a[64:67], v[32:35], v[56:59]
    s_barrier
    v_mfma_f32_16x16x32_bf16 v[60:63], a[68:71], v[32:35], v[60:63]
    v_mfma_f32_16x16x32_bf16 v[64:67], a[72:75], v[32:35], v[64:67]
    v_mfma_f32_16x16x32_bf16 v[68:71], a[76:79], v[32:35], v[68:71]
    s_waitcnt vmcnt(11)
    v_mfma_f32_16x16x32_bf16 v[56:59], a[80:83], v[36:39], v[56:59]
    v_mfma_f32_16x16x32_bf16 v[60:63], a[84:87], v[36:39], v[60:63]
    s_waitcnt vmcnt(9)
    s_cmp_eq_u32 s86, 1
    s_cbranch_scc1 L_sw8
    v_swap_b32 v80, v86
    v_swap_b32 v81, v87
    s_branch L_sx8
L_sw8:
    v_swap_b32 v82, v84
    v_swap_b32 v83, v85
L_sx8:
    v_mfma_f32_16x16x32_bf16 v[64:67], a[88:91], v[36:39], v[64:67]
    v_mfma_f32_16x16x32_bf16 v[68:71], a[92:95], v[36:39], v[68:71]
    v_mfma_f32_16x16x32_bf16 v[56:59], a[96:99], v[80:83], v[56:59]
    v_mfma_f32_16x16x32_bf16 v[60:63], a[100:103], v[80:83], v[60:63]
    v_mfma_f32_16x16x32_bf16 v[64:67], a[104:107], v[80:83], v[64:67]
    v_mfma_f32_16x16x32_bf16 v[68:71], a[108:111], v[80:83], v[68:71]
    s_nop 4
    ds_write_b128 v5, v[56:59] offset:0
    ds_write_b128 v5, v[60:63] offset:1024
    ds_write_b128 v5, v[64:67] offset:2048
    ds_write_b128 v5, v[68:71] offset:3072
    s_waitcnt lgkmcnt(0)
    s_barrier
    ds_read_b128 v[56:59], v6 offset:0
    ds_read_b128 v[60:63], v6 offset:1024
    ds_read_b128 v[64:67], v6 offset:2048
    ds_read_b128 v[68:71], v6 offset:3072
    s_waitcnt vmcnt(0)
    buffer_load_dword v125, v9, s[16:19], s83 offen sc1
    s_waitcnt lgkmcnt(0)
    v_mfma_f32_16x16x32_bf16 v[56:59], a[0:3], v[40:43], v[56:59]
    v_mfma_f32_16x16x32_bf16 v[60:63], a[4:7], v[40:43], v[60:63]
    v_mfma_f32_16x16x32_bf16 v[64:67], a[8:11], v[40:43], v[64:67]
    v_mfma_f32_16x16x32_bf16 v[68:71], a[12:15], v[40:43], v[68:71]
    v_mfma_f32_16x16x32_bf16 v[56:59], a[16:19], v[44:47], v[56:59]
    v_mfma_f32_16x16x32_bf16 v[60:63], a[20:23], v[44:47], v[60:63]
    v_mfma_f32_16x16x32_bf16 v[64:67], a[24:27], v[44:47], v[64:67]
    v_mfma_f32_16x16x32_bf16 v[68:71], a[28:31], v[44:47], v[68:71]
    v_mfma_f32_16x16x32_bf16 v[56:59], a[32:35], a[112:115], v[56:59]
    v_mfma_f32_16x16x32_bf16 v[60:63], a[36:39], a[112:115], v[60:63]
    v_mfma_f32_16x16x32_bf16 v[64:67], a[40:43], a[112:115], v[64:67]
    v_mfma_f32_16x16x32_bf16 v[68:71], a[44:47], a[112:115], v[68:71]
    v_mfma_f32_16x16x32_bf16 v[56:59], a[48:51], a[116:119], v[56:59]
    v_mfma_f32_16x16x32_bf16 v[60:63], a[52:55], a[116:119], v[60:63]
    v_mfma_f32_16x16x32_bf16 v[64:67], a[56:59], a[116:119], v[64:67]
    v_mfma_f32_16x16x32_bf16 v[68:71], a[60:63], a[116:119], v[68:71]
    v_mfma_f32_16x16x32_bf16 v[56:59], a[64:67], a[120:123], v[56:59]
    s_barrier
    v_mfma_f32_16x16x32_bf16 v[60:63], a[68:71], a[120:123], v[60:63]
    v_mfma_f32_16x16x32_bf16 v[64:67], a[72:75], a[120:123], v[64:67]
    v_mfma_f32_16x16x32_bf16 v[68:71], a[76:79], a[120:123], v[68:71]
    v_mfma_f32_16x16x32_bf16 v[56:59], a[80:83], a[124:127], v[56:59]
    v_mfma_f32_16x16x32_bf16 v[60:63], a[84:87], a[124:127], v[60:63]
    v_mfma_f32_16x16x32_bf16 v[64:67], a[88:91], a[124:127], v[64:67]
    v_mfma_f32_16x16x32_bf16 v[68:71], a[92:95], a[124:127], v[68:71]
    v_mfma_f32_16x16x32_bf16 v[56:59], a[96:99], v[84:87], v[56:59]
    v_mfma_f32_16x16x32_bf16 v[60:63], a[100:103], v[84:87], v[60:63]
    v_mfma_f32_16x16x32_bf16 v[64:67], a[104:107], v[84:87], v[64:67]
    v_mfma_f32_16x16x32_bf16 v[68:71], a[108:111], v[84:87], v[68:71]
    s_waitcnt vmcnt(0)
    s_mov_b32 s96, 0
L_chk9:
    v_cmp_ne_u32 vcc, s41, v125
    s_nop 0
    s_cmp_eq_u64 vcc, 0
    s_cbranch_scc1 L_ok9
    s_sleep 1
    buffer_load_dword v125, v9, s[16:19], s83 offen sc1
    s_waitcnt vmcnt(0)
    s_add_u32 s96, s96, 1
    s_cmp_lt_u32 s96, 0x20000
    s_cbranch_scc1 L_chk9
L_ok9:
    s_mov_b32 m0, s91
    s_add_u32 s5, s81, 31744
    buffer_load_dwordx4 v1, s[16:19], s81 offen sc1 lds
    buffer_load_dwordx4 v1, s[16:19], s5 offen offset:1024 sc1 lds
    ds_write_b128 v7, v[64:67] offset:0
    ds_write_b128 v7, v[68:71] offset:1024
    ds_read_b128 v[120:123], v13
    s_waitcnt lgkmcnt(0)
    v_lshlrev_b32 v88, 16, v120
    v_and_b32 v89, 0xffff0000, v120
    v_lshlrev_b32 v90, 16, v121
    v_and_b32 v91, 0xffff0000, v121
    v_lshlrev_b32 v92, 16, v122
    v_and_b32 v93, 0xffff0000, v122
    v_lshlrev_b32 v94, 16, v123
    v_and_b32 v95, 0xffff0000, v123
    s_waitcnt vmcnt(0)
    s_barrier
    ds_read_b64_tr_b16 v[100:101], v11 offset:0
    ds_read_b64_tr_b16 v[102:103], v11 offset:512
    ds_read_b128 v[64:67], v10 offset:0
    ds_read_b128 v[68:71], v10 offset:1024
    s_waitcnt lgkmcnt(2)
    v_lshlrev_b32 v96, 16, v100
    v_and_b32 v97, 0xffff0000, v100
    v_pk_add_f32 v[88:89], v[88:89], v[96:97]
    v_lshlrev_b32 v98, 16, v101
    v_and_b32 v99, 0xffff0000, v101
    v_pk_add_f32 v[90:91], v[90:91], v[98:99]
    v_lshlrev_b32 v96, 16, v102
    v_and_b32 v97, 0xffff0000, v102
    v_pk_add_f32 v[92:93], v[92:93], v[96:97]
    v_lshlrev_b32 v98, 16, v103
    v_and_b32 v99, 0xffff0000, v103
    v_pk_add_f32 v[94:95], v[94:95], v[98:99]
    s_waitcnt lgkmcnt(0)
    v_pk_add_f32 v[56:57], v[56:57], v[64:65]
    v_pk_add_f32 v[58:59], v[58:59], v[66:67]
    v_pk_add_f32 v[60:61], v[60:61], v[68:69]
    v_pk_add_f32 v[62:63], v[62:63], v[70:71]
    v_pk_fma_f32 v[56:57], v[56:57], v[14:15], v[88:89] op_sel:[0,0,0] op_sel_hi:[1,0,1]
    v_pk_fma_f32 v[58:59], v[58:59], v[14:15], v[90:91] op_sel:[0,0,0] op_sel_hi:[1,0,1]
    v_pk_fma_f32 v[60:61], v[60:61], v[14:15], v[92:93] op_sel:[0,0,0] op_sel_hi:[1,0,1]
    v_pk_fma_f32 v[62:63], v[62:63], v[14:15], v[94:95] op_sel:[0,0,0] op_sel_hi:[1,0,1]
    v_cvt_pk_bf16_f32 v120, v56, v57
    v_cvt_pk_bf16_f32 v121, v58, v59
    v_cvt_pk_bf16_f32 v122, v60, v61
    v_cvt_pk_bf16_f32 v123, v62, v63
    buffer_store_dwordx4 v[120:123], v12, s[24:27], 0 offen
    s_endpgm
L_Xr:
    v_mov_b32 v8, 0
    s_mul_i32 s89, s84, 4112
    s_add_u32 s89, s89, 146752
    v_and_b32 v112, 3, v0
    v_lshl_add_u32 v112, v112, 2, s89
    s_add_u32 s89, s89, 16
    s_mul_i32 s4, s84, 27648
    s_add_u32 s4, s4, 65536
    s_lshl_b32 s5, s86, 8
    s_add_u32 s5, s5, s4
    v_lshlrev_b32 v12, 2, v0
    v_xor_b32 v114, 0, v12
    v_add_u32 v114, s5, v114
    v_xor_b32 v115, 16, v12
    v_add_u32 v115, s5, v115
    v_xor_b32 v116, 32, v12
    v_add_u32 v116, s5, v116
    v_xor_b32 v117, 48, v12
    v_add_u32 v117, s5, v117
    v_xor_b32 v118, 64, v12
    v_add_u32 v118, s5, v118
    v_xor_b32 v119, 80, v12
    v_add_u32 v119, s5, v119
    v_xor_b32 v120, 96, v12
    v_add_u32 v120, s5, v120
    v_xor_b32 v121, 112, v12
    v_add_u32 v121, s5, v121
    v_lshrrev_b32 v13, 1, v3
    v_xor_b32 v13, v13, v4
    v_lshlrev_b32 v13, 4, v13
    v_lshl_add_u32 v13, v3, 9, v13
    v_xor_b32 v12, 64, v13
    v_add_u32 v13, s4, v13
    v_add_u32 v12, s4, v12
    s_mul_i32 s4, s86, 8192
    v_add_u32 v14, s4, v13
    v_add_u32 v122, s4, v12
    s_lshl_b32 s4, s86, 4
    v_add_u32 v8, s4, v3
    v_lshlrev_b32 v88, 3, v8
    v_lshl_add_u32 v88, v4, 2, v88
    v_mov_b32 v89, 2
    v_cmp_eq_u32 vcc, 2, v4
    v_lshlrev_b32 v9, 2, v8
    v_add_u32 v9, 256, v9
    v_cndmask_b32 v88, v88, v9, vcc
    v_cmp_eq_u32 vcc, 3, v4
    v_lshlrev_b32 v9, 1, v8
    v_add_u32 v9, 384, v9
    v_cndmask_b32 v88, v88, v9, vcc
    v_cndmask_b32 v89, v89, 64, vcc
    v_add_u32 v89, v88, v89
    v_lshl_add_u32 v88, v88, 2, s89
    v_lshl_add_u32 v89, v89, 2, s89
    v_lshl_add_u32 v90, v4, 7, v8
    v_lshl_add_u32 v90, v90, 2, s89
    s_lshl_b32 s4, s86, 9
    s_sub_u32 s4, 1031, s4
    v_lshlrev_b32 v8, 3, v0
    v_sub_u32 v85, s4, v8
    v_cvt_f32_i32 v10, v85
    v_add_f32 v11, -1.0, v10
    s_sub_u32 s4, s89, 68096
    s_mov_b32 s100, 0xc0000000
    s_mov_b32 s101, 0xc0000000
    v_cvt_pk_bf16_f32 v8, v10, v11
    v_pk_add_f32 v[10:11], v[10:11], s[100:101]
    v_and_b32 v9, 0xffff, v8
    v_lshl_add_u32 v66, v9, 2, s4
    v_lshrrev_b32 v9, 16, v8
    v_lshl_add_u32 v67, v9, 2, s4
    v_cvt_pk_bf16_f32 v8, v10, v11
    v_pk_add_f32 v[10:11], v[10:11], s[100:101]
    v_and_b32 v9, 0xffff, v8
    v_lshl_add_u32 v68, v9, 2, s4
    v_lshrrev_b32 v9, 16, v8
    v_lshl_add_u32 v69, v9, 2, s4
    v_cvt_pk_bf16_f32 v8, v10, v11
    v_pk_add_f32 v[10:11], v[10:11], s[100:101]
    v_and_b32 v9, 0xffff, v8
    v_lshl_add_u32 v70, v9, 2, s4
    v_lshrrev_b32 v9, 16, v8
    v_lshl_add_u32 v71, v9, 2, s4
    v_cvt_pk_bf16_f32 v8, v10, v11
    v_pk_add_f32 v[10:11], v[10:11], s[100:101]
    v_and_b32 v9, 0xffff, v8
    v_lshl_add_u32 v72, v9, 2, s4
    v_lshrrev_b32 v9, 16, v8
    v_lshl_add_u32 v73, v9, 2, s4
    v_cvt_pk_bf16_f32 v8, v10, v11
    v_pk_add_f32 v[10:11], v[10:11], s[100:101]
    v_and_b32 v9, 0xffff, v8
    v_lshl_add_u32 v74, v9, 2, s4
    v_lshrrev_b32 v9, 16, v8
    v_lshl_add_u32 v75, v9, 2, s4
    v_cvt_pk_bf16_f32 v8, v10, v11
    v_and_b32 v9, 0xffff, v8
    v_lshl_add_u32 v76, v9, 2, s4
    v_cmp_eq_u32 vcc, 0x407, v85
    v_lshl_add_u32 v85, v85, 2, s89
    v_add_u32 v85, -44, v85
    v_cndmask_b32 v66, v66, v112, vcc
    v_cndmask_b32 v67, v67, v112, vcc
    v_cndmask_b32 v68, v68, v112, vcc
    s_mul_i32 s4, s84, 9984
    s_add_u32 s4, s4, 65536
    s_lshl_b32 s5, s86, 10
    s_add_u32 s5, s5, s4
    s_add_u32 s5, s5, 240
    v_add_u32 v86, s5, v15
    v_and_b32 v8, 3, v0
    v_mul_u32_u24 v9, 2496, v8
    s_add_u32 s4, s4, 2288
    v_add_u32 v78, s4, v9
    v_lshlrev_b32 v8, 2, v8
    v_sub_u32 v77, s89, v8
    v_lshrrev_b32 v8, 5, v0
    v_mul_u32_u24 v8, 2496, v8
    v_and_b32 v9, 31, v0
    v_lshlrev_b32 v9, 4, v9
    s_mul_i32 s4, s33, 4992
    s_add_u32 s4, s4, 65344
    v_add3_u32 v87, v8, v9, s4
    v_add_u32 v79, 85312, v9
    s_lshl_b32 s4, s33, 6
    v_add_u32 v10, s4, v0
    s_movk_i32 s4, 3641
    v_mul_u32_u24 v11, s4, v10
    v_lshrrev_b32 v11, 16, v11
    v_mul_u32_u24 v8, 18, v11
    v_sub_u32 v8, v10, v8
    v_lshrrev_b32 v9, 1, v8
    v_xor_b32 v8, v8, v9
    v_and_b32 v8, 1, v8
    v_lshl_add_u32 v11, v11, 3, v9
    v_lshlrev_b32 v8, 4, v8
    v_lshl_add_u32 v106, v11, 13, v8
    v_add_u32 v10, 256, v10
    v_mul_u32_u24 v11, s4, v10
    v_lshrrev_b32 v11, 16, v11
    v_mul_u32_u24 v8, 18, v11
    v_sub_u32 v8, v10, v8
    v_lshrrev_b32 v9, 1, v8
    v_xor_b32 v8, v8, v9
    v_and_b32 v8, 1, v8
    v_lshl_add_u32 v11, v11, 3, v9
    v_lshlrev_b32 v8, 4, v8
    v_lshl_add_u32 v107, v11, 13, v8
    v_add_u32 v10, 512, v0
    v_mul_u32_u24 v11, s4, v10
    v_lshrrev_b32 v11, 16, v11
    v_mul_u32_u24 v8, 18, v11
    v_sub_u32 v8, v10, v8
    v_lshrrev_b32 v9, 1, v8
    v_xor_b32 v8, v8, v9
    v_and_b32 v8, 1, v8
    v_lshl_add_u32 v11, v11, 3, v9
    v_lshlrev_b32 v8, 4, v8
    v_lshl_add_u32 v108, v11, 13, v8
    s_and_b32 s4, s38, 1
    s_lshl_b32 s4, s4, 12
    s_lshr_b32 s5, s38, 1
    s_lshl_b32 s5, s5, 5
    s_add_u32 s77, s5, s4
    s_lshl_b32 s4, s33, 10
    s_add_u32 s76, s4, 137504
    s_add_u32 s4, s4, 132608
    v_add_u32 v111, s4, v15
    s_waitcnt vmcnt(0)
    s_waitcnt lgkmcnt(0)
    s_and_b32 s4, s85, 1
    s_lshl_b32 s4, s4, 4
    s_lshr_b32 s87, s87, s4
    s_lshl_b32 s87, s87, 16
    s_lshr_b32 s88, s88, s4
    s_lshl_b32 s88, s88, 16
    v_mov_b32 v30, s87
    v_and_b32 v25, 0xffff0000, v25
    v_and_b32 v24, 0xffff0000, v24
    v_mul_f32 v30, 0x3fb8aa3b, v30
    v_and_b32 v26, 0xffff0000, v26
    v_and_b32 v27, 0xffff0000, v27
    v_exp_f32 v30, v30
    v_and_b32 v28, 0xffff0000, v28
    v_and_b32 v29, 0xffff0000, v29
    v_mov_b32 v40, 1.0
    v_mov_b32 v41, 0
    v_cvt_pk_bf16_f32 v30, v30, v30
    v_pk_mul_f32 v[32:33], v[28:29], v[26:27] op_sel:[0,0] op_sel_hi:[0,1]
    v_cvt_pk_bf16_f32 v16, v40, v41
    v_and_b32 v30, 0xffff0000, v30
    v_pk_fma_f32 v[32:33], v[28:29], v[26:27], v[32:33] op_sel:[1,1,0] op_sel_hi:[1,0,1] neg_lo:[1,0,0]
    v_mul_f32 v25, v25, v30
    v_mul_f32 v24, v24, v30
    v_mul_f32 v32, v32, v30
    v_mul_f32 v25, 0.15915494, v25
    v_mul_f32 v24, 0x3fb8aa3b, v24
    v_mul_f32 v33, v33, v30
    v_mul_f32 v45, 0x41000000, v25
    v_mul_f32 v44, 0x41000000, v24
    v_fract_f32 v47, v25
    v_fract_f32 v45, v45
    v_exp_f32 v44, v44
    v_mul_f32 v49, 0x43800000, v25
    v_cos_f32 v36, v45
    v_sin_f32 v37, v45
    v_exp_f32 v46, v24
    v_cos_f32 v34, v47
    v_sin_f32 v35, v47
    v_mul_f32 v36, v36, v44
    v_mul_f32 v37, v37, v44
    v_mul_f32 v48, 0x43800000, v24
    v_fract_f32 v49, v49
    v_pk_mul_f32 v[44:45], v[36:37], v[36:37] op_sel:[0,0] op_sel_hi:[0,1]
    v_mul_f32 v34, v34, v46
    v_mul_f32 v35, v35, v46
    v_exp_f32 v48, v48
    v_cos_f32 v38, v49
    v_sin_f32 v39, v49
    v_pk_fma_f32 v[22:23], v[36:37], v[36:37], v[44:45] op_sel:[1,1,0] op_sel_hi:[1,0,1] neg_lo:[1,0,0]
    v_mov_b32 v20, v36
    v_mov_b32 v21, v37
    v_mul_f32 v38, v38, v48
    v_mul_f32 v39, v39, v48
    v_cvt_pk_bf16_f32 v17, v20, v21
    v_pk_mul_f32 v[44:45], v[40:41], v[22:23] op_sel:[0,0] op_sel_hi:[0,1]
    v_pk_mul_f32 v[46:47], v[20:21], v[22:23] op_sel:[0,0] op_sel_hi:[0,1]
    v_pk_mul_f32 v[48:49], v[32:33], v[34:35] op_sel:[0,0] op_sel_hi:[0,1]
    v_pk_fma_f32 v[40:41], v[40:41], v[22:23], v[44:45] op_sel:[1,1,0] op_sel_hi:[1,0,1] neg_lo:[1,0,0]
    v_pk_fma_f32 v[20:21], v[20:21], v[22:23], v[46:47] op_sel:[1,1,0] op_sel_hi:[1,0,1] neg_lo:[1,0,0]
    v_pk_fma_f32 v[50:51], v[32:33], v[34:35], v[48:49] op_sel:[1,1,0] op_sel_hi:[1,0,1] neg_lo:[1,0,0]
    v_cvt_pk_bf16_f32 v62, v40, v41
    v_cvt_pk_bf16_f32 v63, v20, v21
    v_pk_mul_f32 v[44:45], v[40:41], v[22:23] op_sel:[0,0] op_sel_hi:[0,1]
    v_pk_mul_f32 v[46:47], v[20:21], v[22:23] op_sel:[0,0] op_sel_hi:[0,1]
    ds_write2st64_b32 v114, v16, v17 offset0:0 offset1:2
    v_pk_fma_f32 v[40:41], v[40:41], v[22:23], v[44:45] op_sel:[1,1,0] op_sel_hi:[1,0,1] neg_lo:[1,0,0]
    v_pk_fma_f32 v[20:21], v[20:21], v[22:23], v[46:47] op_sel:[1,1,0] op_sel_hi:[1,0,1] neg_lo:[1,0,0]
    v_pk_mul_f32 v[48:49], v[50:51], v[34:35] op_sel:[0,0] op_sel_hi:[0,1]
    v_cvt_pk_bf16_f32 v16, v40, v41
    v_cvt_pk_bf16_f32 v17, v20, v21
    v_pk_fma_f32 v[52:53], v[50:51], v[34:35], v[48:49] op_sel:[1,1,0] op_sel_hi:[1,0,1] neg_lo:[1,0,0]
    v_pk_mul_f32 v[44:45], v[40:41], v[22:23] op_sel:[0,0] op_sel_hi:[0,1]
    v_pk_mul_f32 v[46:47], v[20:21], v[22:23] op_sel:[0,0] op_sel_hi:[0,1]
    v_cvt_pk_bf16_f32 v18, v32, -v33
    ds_write2st64_b32 v115, v62, v63 offset0:4 offset1:6
    v_cvt_pk_bf16_f32 v19, v50, -v51
    v_pk_fma_f32 v[40:41], v[40:41], v[22:23], v[44:45] op_sel:[1,1,0] op_sel_hi:[1,0,1] neg_lo:[1,0,0]
    v_pk_fma_f32 v[20:21], v[20:21], v[22:23], v[46:47] op_sel:[1,1,0] op_sel_hi:[1,0,1] neg_lo:[1,0,0]
    v_pk_mul_f32 v[48:49], v[52:53], v[34:35] op_sel:[0,0] op_sel_hi:[0,1]
    ds_write2st64_b32 v114, v18, v19 offset0:64 offset1:66
    v_cvt_pk_bf16_f32 v62, v40, v41
    v_pk_fma_f32 v[50:51], v[52:53], v[34:35], v[48:49] op_sel:[1,1,0] op_sel_hi:[1,0,1] neg_lo:[1,0,0]
    v_cvt_pk_bf16_f32 v63, v20, v21
    v_pk_mul_f32 v[44:45], v[40:41], v[22:23] op_sel:[0,0] op_sel_hi:[0,1]
    v_pk_mul_f32 v[46:47], v[20:21], v[22:23] op_sel:[0,0] op_sel_hi:[0,1]
    ds_write2st64_b32 v116, v16, v17 offset0:8 offset1:10
    v_pk_fma_f32 v[40:41], v[40:41], v[22:23], v[44:45] op_sel:[1,1,0] op_sel_hi:[1,0,1] neg_lo:[1,0,0]
    v_pk_fma_f32 v[20:21], v[20:21], v[22:23], v[46:47] op_sel:[1,1,0] op_sel_hi:[1,0,1] neg_lo:[1,0,0]
    v_pk_mul_f32 v[48:49], v[50:51], v[34:35] op_sel:[0,0] op_sel_hi:[0,1]
    v_pk_mul_f32 v[28:29], v[38:39], v[38:39] op_sel:[0,0] op_sel_hi:[0,1]
    v_cvt_pk_bf16_f32 v16, v40, v41
    v_pk_fma_f32 v[54:55], v[50:51], v[34:35], v[48:49] op_sel:[1,1,0] op_sel_hi:[1,0,1] neg_lo:[1,0,0]
    v_cvt_pk_bf16_f32 v17, v20, v21
    v_pk_mul_f32 v[44:45], v[40:41], v[22:23] op_sel:[0,0] op_sel_hi:[0,1]
    v_pk_mul_f32 v[46:47], v[20:21], v[22:23] op_sel:[0,0] op_sel_hi:[0,1]
    v_pk_fma_f32 v[42:43], v[38:39], v[38:39], v[28:29] op_sel:[1,1,0] op_sel_hi:[1,0,1] neg_lo:[1,0,0]
    v_cvt_pk_bf16_f32 v64, v52, -v53
    ds_write2st64_b32 v117, v62, v63 offset0:12 offset1:14
    v_cvt_pk_bf16_f32 v65, v50, -v51
    v_pk_fma_f32 v[40:41], v[40:41], v[22:23], v[44:45] op_sel:[1,1,0] op_sel_hi:[1,0,1] neg_lo:[1,0,0]
    v_pk_fma_f32 v[20:21], v[20:21], v[22:23], v[46:47] op_sel:[1,1,0] op_sel_hi:[1,0,1] neg_lo:[1,0,0]
    v_pk_mul_f32 v[48:49], v[54:55], v[34:35] op_sel:[0,0] op_sel_hi:[0,1]
    v_pk_mul_f32 v[28:29], v[32:33], v[42:43] op_sel:[0,0] op_sel_hi:[0,1]
    ds_write2st64_b32 v115, v64, v65 offset0:68 offset1:70
    v_pk_fma_f32 v[50:51], v[54:55], v[34:35], v[48:49] op_sel:[1,1,0] op_sel_hi:[1,0,1] neg_lo:[1,0,0]
    v_cvt_pk_bf16_f32 v62, v40, v41
    v_cvt_pk_bf16_f32 v63, v20, v21
    v_pk_mul_f32 v[44:45], v[40:41], v[22:23] op_sel:[0,0] op_sel_hi:[0,1]
    v_pk_mul_f32 v[46:47], v[20:21], v[22:23] op_sel:[0,0] op_sel_hi:[0,1]
    v_pk_fma_f32 v[58:59], v[32:33], v[42:43], v[28:29] op_sel:[1,1,0] op_sel_hi:[1,0,1] neg_lo:[1,0,0]
    ds_write2st64_b32 v118, v16, v17 offset0:16 offset1:18
    v_pk_fma_f32 v[40:41], v[40:41], v[22:23], v[44:45] op_sel:[1,1,0] op_sel_hi:[1,0,1] neg_lo:[1,0,0]
    v_pk_fma_f32 v[20:21], v[20:21], v[22:23], v[46:47] op_sel:[1,1,0] op_sel_hi:[1,0,1] neg_lo:[1,0,0]
    v_pk_mul_f32 v[48:49], v[50:51], v[34:35] op_sel:[0,0] op_sel_hi:[0,1]
    v_cvt_pk_bf16_f32 v30, v58, -v59
    v_pk_mul_f32 v[28:29], v[58:59], v[38:39] op_sel:[0,0] op_sel_hi:[0,1]
    v_pk_fma_f32 v[56:57], v[50:51], v[34:35], v[48:49] op_sel:[1,1,0] op_sel_hi:[1,0,1] neg_lo:[1,0,0]
    v_cvt_pk_bf16_f32 v16, v40, v41
    v_cvt_pk_bf16_f32 v17, v20, v21
    v_pk_mul_f32 v[44:45], v[40:41], v[22:23] op_sel:[0,0] op_sel_hi:[0,1]
    v_pk_mul_f32 v[46:47], v[20:21], v[22:23] op_sel:[0,0] op_sel_hi:[0,1]
    v_pk_fma_f32 v[58:59], v[58:59], v[38:39], v[28:29] op_sel:[1,1,0] op_sel_hi:[1,0,1] neg_lo:[1,0,0]
    v_cvt_pk_bf16_f32 v18, v54, -v55
    ds_write2st64_b32 v119, v62, v63 offset0:20 offset1:22
    v_cvt_pk_bf16_f32 v19, v50, -v51
    v_pk_fma_f32 v[40:41], v[40:41], v[22:23], v[44:45] op_sel:[1,1,0] op_sel_hi:[1,0,1] neg_lo:[1,0,0]
    v_pk_fma_f32 v[20:21], v[20:21], v[22:23], v[46:47] op_sel:[1,1,0] op_sel_hi:[1,0,1] neg_lo:[1,0,0]
    v_pk_mul_f32 v[48:49], v[56:57], v[34:35] op_sel:[0,0] op_sel_hi:[0,1]
    v_cvt_pk_bf16_f32 v8, v58, -v59
    ds_write2st64_b32 v116, v18, v19 offset0:72 offset1:74
    v_pk_mul_f32 v[28:29], v[58:59], v[38:39] op_sel:[0,0] op_sel_hi:[0,1]
    v_pk_fma_f32 v[50:51], v[56:57], v[34:35], v[48:49] op_sel:[1,1,0] op_sel_hi:[1,0,1] neg_lo:[1,0,0]
    v_cvt_pk_bf16_f32 v62, v40, v41
    v_cvt_pk_bf16_f32 v63, v20, v21
    v_pk_mul_f32 v[44:45], v[40:41], v[22:23] op_sel:[0,0] op_sel_hi:[0,1]
    s_barrier
    v_pk_mul_f32 v[46:47], v[20:21], v[22:23] op_sel:[0,0] op_sel_hi:[0,1]
    v_pk_fma_f32 v[58:59], v[58:59], v[38:39], v[28:29] op_sel:[1,1,0] op_sel_hi:[1,0,1] neg_lo:[1,0,0]
    ds_write2st64_b32 v120, v16, v17 offset0:24 offset1:26
    v_pk_fma_f32 v[40:41], v[40:41], v[22:23], v[44:45] op_sel:[1,1,0] op_sel_hi:[1,0,1] neg_lo:[1,0,0]
    v_pk_fma_f32 v[20:21], v[20:21], v[22:23], v[46:47] op_sel:[1,1,0] op_sel_hi:[1,0,1] neg_lo:[1,0,0]
    v_cvt_pk_bf16_f32 v65, v50, -v51
    v_pk_mul_f32 v[48:49], v[32:33], v[38:39] op_sel:[0,0] op_sel_hi:[0,1]
    v_cvt_pk_bf16_f32 v64, v56, -v57
    v_cvt_pk_bf16_f32 v24, v58, -v59
    ds_write2st64_b32 v121, v62, v63 offset0:28 offset1:30
    v_pk_fma_f32 v[50:51], v[32:33], v[38:39], v[48:49] op_sel:[1,1,0] op_sel_hi:[1,0,1] neg_lo:[1,0,0]
    v_pk_mul_f32 v[28:29], v[58:59], v[38:39] op_sel:[0,0] op_sel_hi:[0,1]
    v_cvt_pk_bf16_f32 v16, v40, v41
    v_cvt_pk_bf16_f32 v17, v20, v21
    v_pk_mul_f32 v[44:45], v[40:41], v[22:23] op_sel:[0,0] op_sel_hi:[0,1]
    v_pk_mul_f32 v[46:47], v[20:21], v[22:23] op_sel:[0,0] op_sel_hi:[0,1]
    ds_write2st64_b32 v117, v64, v65 offset0:76 offset1:78
    v_pk_fma_f32 v[58:59], v[58:59], v[38:39], v[28:29] op_sel:[1,1,0] op_sel_hi:[1,0,1] neg_lo:[1,0,0]
    v_pk_fma_f32 v[40:41], v[40:41], v[22:23], v[44:45] op_sel:[1,1,0] op_sel_hi:[1,0,1] neg_lo:[1,0,0]
    v_pk_fma_f32 v[20:21], v[20:21], v[22:23], v[46:47] op_sel:[1,1,0] op_sel_hi:[1,0,1] neg_lo:[1,0,0]
    v_pk_mul_f32 v[48:49], v[52:53], v[38:39] op_sel:[0,0] op_sel_hi:[0,1]
    ds_write2st64_b32 v114, v16, v17 offset0:32 offset1:34
    v_cvt_pk_bf16_f32 v25, v58, -v59
    v_pk_fma_f32 v[26:27], v[52:53], v[38:39], v[48:49] op_sel:[1,1,0] op_sel_hi:[1,0,1] neg_lo:[1,0,0]
    v_cvt_pk_bf16_f32 v62, v40, v41
    v_cvt_pk_bf16_f32 v63, v20, v21
    v_pk_mul_f32 v[44:45], v[40:41], v[22:23] op_sel:[0,0] op_sel_hi:[0,1]
    v_pk_mul_f32 v[46:47], v[20:21], v[22:23] op_sel:[0,0] op_sel_hi:[0,1]
    v_cvt_pk_bf16_f32 v18, v50, -v51
    ds_write2st64_b32 v114, v24, v25 offset0:96 offset1:98
    v_pk_fma_f32 v[40:41], v[40:41], v[22:23], v[44:45] op_sel:[1,1,0] op_sel_hi:[1,0,1] neg_lo:[1,0,0]
    v_pk_fma_f32 v[20:21], v[20:21], v[22:23], v[46:47] op_sel:[1,1,0] op_sel_hi:[1,0,1] neg_lo:[1,0,0]
    v_pk_mul_f32 v[48:49], v[54:55], v[38:39] op_sel:[0,0] op_sel_hi:[0,1]
    ds_write2st64_b32 v115, v62, v63 offset0:36 offset1:38
    v_cvt_pk_bf16_f32 v19, v26, -v27
    v_pk_fma_f32 v[50:51], v[54:55], v[38:39], v[48:49] op_sel:[1,1,0] op_sel_hi:[1,0,1] neg_lo:[1,0,0]
    v_cvt_pk_bf16_f32 v16, v40, v41
    v_cvt_pk_bf16_f32 v17, v20, v21
    v_pk_mul_f32 v[44:45], v[40:41], v[22:23] op_sel:[0,0] op_sel_hi:[0,1]
    v_pk_mul_f32 v[46:47], v[20:21], v[22:23] op_sel:[0,0] op_sel_hi:[0,1]
    ds_write2st64_b32 v118, v18, v19 offset0:80 offset1:82
    v_pk_fma_f32 v[40:41], v[40:41], v[22:23], v[44:45] op_sel:[1,1,0] op_sel_hi:[1,0,1] neg_lo:[1,0,0]
    v_pk_fma_f32 v[20:21], v[20:21], v[22:23], v[46:47] op_sel:[1,1,0] op_sel_hi:[1,0,1] neg_lo:[1,0,0]
    v_pk_mul_f32 v[48:49], v[56:57], v[38:39] op_sel:[0,0] op_sel_hi:[0,1]
    v_pk_mul_f32 v[28:29], v[58:59], v[38:39] op_sel:[0,0] op_sel_hi:[0,1]
    ds_write2st64_b32 v116, v16, v17 offset0:40 offset1:42
    v_pk_fma_f32 v[26:27], v[56:57], v[38:39], v[48:49] op_sel:[1,1,0] op_sel_hi:[1,0,1] neg_lo:[1,0,0]
    v_cvt_pk_bf16_f32 v62, v40, v41
    v_cvt_pk_bf16_f32 v63, v20, v21
    v_pk_mul_f32 v[44:45], v[40:41], v[22:23] op_sel:[0,0] op_sel_hi:[0,1]
    v_pk_mul_f32 v[46:47], v[20:21], v[22:23] op_sel:[0,0] op_sel_hi:[0,1]
    v_pk_fma_f32 v[58:59], v[58:59], v[38:39], v[28:29] op_sel:[1,1,0] op_sel_hi:[1,0,1] neg_lo:[1,0,0]
    v_cvt_pk_bf16_f32 v64, v50, -v51
    ds_write2st64_b32 v117, v62, v63 offset0:44 offset1:46
    v_pk_fma_f32 v[40:41], v[40:41], v[22:23], v[44:45] op_sel:[1,1,0] op_sel_hi:[1,0,1] neg_lo:[1,0,0]
    v_pk_fma_f32 v[20:21], v[20:21], v[22:23], v[46:47] op_sel:[1,1,0] op_sel_hi:[1,0,1] neg_lo:[1,0,0]
    v_cvt_pk_bf16_f32 v65, v26, -v27
    v_pk_mul_f32 v[48:49], v[54:55], v[42:43] op_sel:[0,0] op_sel_hi:[0,1]
    v_cvt_pk_bf16_f32 v10, v58, -v59
    ds_write2st64_b32 v119, v64, v65 offset0:84 offset1:86
    v_pk_fma_f32 v[60:61], v[54:55], v[42:43], v[48:49] op_sel:[1,1,0] op_sel_hi:[1,0,1] neg_lo:[1,0,0]
    v_pk_mul_f32 v[28:29], v[58:59], v[38:39] op_sel:[0,0] op_sel_hi:[0,1]
    v_cvt_pk_bf16_f32 v16, v40, v41
    v_cvt_pk_bf16_f32 v17, v20, v21
    v_pk_fma_f32 v[58:59], v[58:59], v[38:39], v[28:29] op_sel:[1,1,0] op_sel_hi:[1,0,1] neg_lo:[1,0,0]
    v_pk_mul_f32 v[44:45], v[40:41], v[22:23] op_sel:[0,0] op_sel_hi:[0,1]
    ds_write2st64_b32 v118, v16, v17 offset0:48 offset1:50
    v_pk_mul_f32 v[46:47], v[20:21], v[22:23] op_sel:[0,0] op_sel_hi:[0,1]
    v_cvt_pk_bf16_f32 v31, v60, -v61
    v_pk_fma_f32 v[40:41], v[40:41], v[22:23], v[44:45] op_sel:[1,1,0] op_sel_hi:[1,0,1] neg_lo:[1,0,0]
    v_pk_fma_f32 v[20:21], v[20:21], v[22:23], v[46:47] op_sel:[1,1,0] op_sel_hi:[1,0,1] neg_lo:[1,0,0]
    ds_write2st64_b32 v120, v30, v31 offset0:88 offset1:90
    v_pk_mul_f32 v[48:49], v[60:61], v[38:39] op_sel:[0,0] op_sel_hi:[0,1]
    v_cvt_pk_bf16_f32 v11, v58, -v59
    v_cvt_pk_bf16_f32 v62, v40, v41
    v_pk_fma_f32 v[60:61], v[60:61], v[38:39], v[48:49] op_sel:[1,1,0] op_sel_hi:[1,0,1] neg_lo:[1,0,0]
    ds_write2st64_b32 v115, v10, v11 offset0:100 offset1:102
    v_cvt_pk_bf16_f32 v63, v20, v21
    v_pk_mul_f32 v[44:45], v[40:41], v[22:23] op_sel:[0,0] op_sel_hi:[0,1]
    v_pk_mul_f32 v[46:47], v[20:21], v[22:23] op_sel:[0,0] op_sel_hi:[0,1]
    ds_write2st64_b32 v119, v62, v63 offset0:52 offset1:54
    v_pk_fma_f32 v[40:41], v[40:41], v[22:23], v[44:45] op_sel:[1,1,0] op_sel_hi:[1,0,1] neg_lo:[1,0,0]
    v_pk_fma_f32 v[20:21], v[20:21], v[22:23], v[46:47] op_sel:[1,1,0] op_sel_hi:[1,0,1] neg_lo:[1,0,0]
    v_cvt_pk_bf16_f32 v9, v60, -v61
    v_pk_mul_f32 v[28:29], v[58:59], v[38:39] op_sel:[0,0] op_sel_hi:[0,1]
    v_cvt_pk_bf16_f32 v16, v40, v41
    ds_write2st64_b32 v121, v8, v9 offset0:92 offset1:94
    v_pk_fma_f32 v[58:59], v[58:59], v[38:39], v[28:29] op_sel:[1,1,0] op_sel_hi:[1,0,1] neg_lo:[1,0,0]
    v_cvt_pk_bf16_f32 v17, v20, v21
    v_pk_mul_f32 v[44:45], v[40:41], v[22:23] op_sel:[0,0] op_sel_hi:[0,1]
    v_pk_mul_f32 v[46:47], v[20:21], v[22:23] op_sel:[0,0] op_sel_hi:[0,1]
    ds_write2st64_b32 v120, v16, v17 offset0:56 offset1:58
    v_pk_fma_f32 v[40:41], v[40:41], v[22:23], v[44:45] op_sel:[1,1,0] op_sel_hi:[1,0,1] neg_lo:[1,0,0]
    v_pk_fma_f32 v[20:21], v[20:21], v[22:23], v[46:47] op_sel:[1,1,0] op_sel_hi:[1,0,1] neg_lo:[1,0,0]
    v_cvt_pk_bf16_f32 v24, v58, -v59
    v_cvt_pk_bf16_f32 v62, v40, v41
    v_cvt_pk_bf16_f32 v63, v20, v21
    ds_write_b32 v116, v24 offset:26624
    ds_write2st64_b32 v121, v62, v63 offset0:60 offset1:62
    v_mov_b32 v8, 0
    buffer_load_dword v124, v8, s[28:31], 0 offen sc1
    s_waitcnt lgkmcnt(0)
    s_barrier
    s_barrier
    s_add_u32 s97, s43, 4
    s_and_b32 s97, s97, 15
    s_mul_i32 s4, s97, 114688
    s_add_u32 m0, s7, 0
    s_add_u32 s5, s4, 56320
    buffer_load_dwordx4 v7, s[12:15], s4 offen offset:2048 lds
    buffer_load_dwordx4 v7, s[12:15], s5 offen offset:3072 lds
    s_barrier
    s_add_u32 s97, s43, 4
    s_and_b32 s97, s97, 15
    s_lshl_b32 s4, s97, 6
    s_add_u32 m0, s7, 0
    s_add_u32 s5, s4, 15360
    buffer_load_dwordx4 v5, s[8:11], s4 offen lds
    buffer_load_dwordx4 v5, s[8:11], s5 offen offset:1024 lds
    s_add_u32 m0, s7, 16384
    s_add_u32 s4, s4, 64
    s_add_u32 s5, s5, 64
    buffer_load_dwordx4 v5, s[8:11], s4 offen lds
    buffer_load_dwordx4 v5, s[8:11], s5 offen offset:1024 lds
    s_add_u32 s97, s43, 5
    s_and_b32 s97, s97, 15
    s_mul_i32 s4, s97, 114688
    s_add_u32 m0, s7, 16384
    s_add_u32 s5, s4, 56320
    buffer_load_dwordx4 v7, s[12:15], s4 offen offset:2048 lds
    buffer_load_dwordx4 v7, s[12:15], s5 offen offset:3072 lds
    s_barrier
    s_add_u32 s97, s43, 6
    s_and_b32 s97, s97, 15
    s_mul_i32 s4, s97, 114688
    s_add_u32 m0, s7, 32768
    s_add_u32 s5, s4, 56320
    buffer_load_dwordx4 v7, s[12:15], s4 offen offset:2048 lds
    buffer_load_dwordx4 v7, s[12:15], s5 offen offset:3072 lds
    v_mov_b32 v8, 0
    v_mov_b32 v9, 0
    v_mov_b32 v10, 0
    v_mov_b32 v11, 0
    s_cmp_eq_u32 s86, 0
    s_cselect_b32 s95, -1, 0xffff
    s_mov_b32 s94, -1
    ds_write_b128 v111, v[8:11]
    ds_write_b128 v111, v[8:11] offset:1024
    ds_write_b32 v112, v8
    s_waitcnt vmcnt(6)
    s_barrier
    s_add_u32 s97, s43, 6
    s_and_b32 s97, s97, 15
    s_lshl_b32 s4, s97, 6
    s_add_u32 m0, s7, 32768
    s_add_u32 s5, s4, 15360
    buffer_load_dwordx4 v5, s[8:11], s4 offen lds
    buffer_load_dwordx4 v5, s[8:11], s5 offen offset:1024 lds
    s_add_u32 m0, s7, 49152
    s_add_u32 s4, s4, 64
    s_add_u32 s5, s5, 64
    buffer_load_dwordx4 v5, s[8:11], s4 offen lds
    buffer_load_dwordx4 v5, s[8:11], s5 offen offset:1024 lds
    s_add_u32 s97, s43, 7
    s_and_b32 s97, s97, 15
    s_mul_i32 s4, s97, 114688
    s_add_u32 m0, s7, 49152
    s_add_u32 s5, s4, 56320
    buffer_load_dwordx4 v7, s[12:15], s4 offen offset:2048 lds
    buffer_load_dwordx4 v7, s[12:15], s5 offen offset:3072 lds
    s_mul_i32 s53, s33, 14
    s_lshl3_add_u32 s53, s53, s40
    s_lshl_b32 s53, s53, 12
    s_add_u32 s78, s53, 14680064
    s_lshl_b32 s55, s33, 14
    v_add_u32 v109, s55, v15
    s_mul_i32 s53, s84, 9984
    s_add_u32 s53, s53, 65536
    s_lshl_b32 s54, s33, 13
    s_add_u32 s55, s54, 103936
    v_add_u32 v93, s55, v15
    s_xor_b32 s54, s54, 0x2000
    s_add_u32 s55, s54, 103936
    v_add_u32 v94, s55, v15
    v_sub_u32 v8, 3, v3
    v_and_b32 v8, 3, v8
    v_mul_u32_u24 v91, 2494, v8
    v_lshlrev_b32 v9, 1, v3
    v_sub_u32 v91, v91, v9
    v_lshl_add_u32 v91, v4, 4, v91
    s_add_u32 s53, s53, 2334
    s_movk_i32 s54, 2304
    s_cmp_eq_u32 s86, 0
    s_cselect_b32 s54, s54, 1152
    s_sub_u32 s53, s53, s54
    v_add_u32 v91, s53, v91
    s_waitcnt vmcnt(8)
    s_barrier
    s_add_u32 s97, s43, 8
    s_and_b32 s97, s97, 15
    s_mul_i32 s4, s97, 114688
    s_add_u32 m0, s7, 0
    s_add_u32 s5, s4, 56320
    buffer_load_dwordx4 v7, s[12:15], s4 offen offset:2048 lds
    buffer_load_dwordx4 v7, s[12:15], s5 offen offset:3072 lds
    v_mul_u32_u24 v10, 18, v3
    v_and_b32 v8, 1, v4
    v_xor_b32 v9, s84, v8
    v_lshl_add_u32 v9, v4, 1, v9
    v_add_lshl_u32 v92, v10, v9, 4
    s_cmp_eq_u32 s86, 0
    s_cselect_b32 s54, 0, 2592
    s_add_u32 s53, s54, 132608
    v_add_u32 v92, s53, v92
    v_lshrrev_b32 v9, 1, v4
    v_xor_b32 v11, s84, v9
    v_lshl_add_u32 v11, v9, 1, v11
    v_add_lshl_u32 v95, v10, v11, 4
    v_lshl_add_u32 v95, v8, 3, v95
    s_mul_i32 s53, s86, 4608
    s_add_u32 s53, s53, 137504
    v_add_u32 v95, s53, v95
    v_lshlrev_b32 v96, 7, v3
    v_lshl_add_u32 v96, v8, 5, v96
    v_lshl_add_u32 v96, v9, 4, v96
    v_lshlrev_b32 v97, 7, v0
    s_lshl_b32 s53, s85, 12
    s_lshl_b32 s54, s86, 11
    s_add_u32 s53, s53, s54
    s_add_u32 s80, s53, 2097152
    s_waitcnt vmcnt(6)
    s_barrier
    s_add_u32 s97, s43, 8
    s_and_b32 s97, s97, 15
    s_lshl_b32 s4, s97, 6
    s_add_u32 m0, s7, 0
    s_add_u32 s5, s4, 15360
    buffer_load_dwordx4 v5, s[8:11], s4 offen lds
    buffer_load_dwordx4 v5, s[8:11], s5 offen offset:1024 lds
    s_add_u32 m0, s7, 16384
    s_add_u32 s4, s4, 64
    s_add_u32 s5, s5, 64
    buffer_load_dwordx4 v5, s[8:11], s4 offen lds
    buffer_load_dwordx4 v5, s[8:11], s5 offen offset:1024 lds
    s_add_u32 s97, s43, 9
    s_and_b32 s97, s97, 15
    s_mul_i32 s4, s97, 114688
    s_add_u32 m0, s7, 16384
    s_add_u32 s5, s4, 56320
    buffer_load_dwordx4 v7, s[12:15], s4 offen offset:2048 lds
    buffer_load_dwordx4 v7, s[12:15], s5 offen offset:3072 lds
    s_lshl_b32 s53, s86, 9
    s_add_u32 s53, s53, s85
    s_lshl_b32 s53, s53, 5
    s_add_u32 s93, s53, 12845056
    v_lshrrev_b32 v10, 2, v3
    v_lshl_add_u32 v10, v4, 3, v10
    v_lshlrev_b32 v10, 5, v10
    v_and_b32 v11, 3, v3
    v_lshl_add_u32 v10, v11, 3, v10
    s_mul_i32 s53, s84, 4352
    s_lshl_b32 s54, s86, 10
    s_add_u32 s53, s53, s54
    s_add_u32 s53, s53, 85760
    v_add_u32 v83, s53, v10
    v_lshlrev_b32 v10, 4, v4
    v_lshlrev_b32 v11, 3, v3
    v_sub_u32 v10, v10, v11
    s_lshl_b32 s53, s84, 11
    s_lshl_b32 s54, s86, 6
    s_add_u32 s53, s53, s54
    s_add_u32 s53, s53, 94584
    v_add_u32 v84, s53, v10
    s_mul_i32 s54, s39, 224
    s_mul_i32 s53, s33, 14
    s_add_u32 s54, s54, s53
    s_lshl_b32 s54, s54, 10
    s_add_u32 s54, s54, 4194304
    s_xor_b32 s53, s33, 3
    s_mul_i32 s53, s53, 57344
    s_add_u32 s70, s53, s54
    s_xor_b32 s53, s33, 2
    s_mul_i32 s53, s53, 57344
    s_add_u32 s71, s53, s54
    s_waitcnt vmcnt(8)
    s_barrier
    s_add_u32 s97, s43, 10
    s_and_b32 s97, s97, 15
    s_mul_i32 s4, s97, 114688
    s_add_u32 m0, s7, 32768
    s_add_u32 s5, s4, 56320
    buffer_load_dwordx4 v7, s[12:15], s4 offen offset:2048 lds
    buffer_load_dwordx4 v7, s[12:15], s5 offen offset:3072 lds
    s_xor_b32 s53, s33, 1
    s_mul_i32 s53, s53, 57344
    s_add_u32 s72, s53, s54
    s_xor_b32 s53, s33, 0
    s_mul_i32 s53, s53, 57344
    s_add_u32 s73, s53, s54
    s_lshl_b32 s53, s39, 15
    s_add_u32 s53, s53, s7
    s_add_u32 s53, s53, 16779264
    s_lshl_b32 s54, s84, 14
    s_add_u32 s46, s53, s54
    s_xor_b32 s54, s54, 0x4000
    s_add_u32 s44, s53, s54
    s_lshl_b32 s53, s86, 10
    s_add_u32 s45, s44, s53
    s_add_u32 s47, s46, s53
    s_xor_b32 s53, s53, 0x400
    s_add_u32 s44, s44, s53
    s_add_u32 s46, s46, s53
    s_lshl_b32 s53, s33, 11
    s_add_u32 s91, s53, 65536
    s_lshl_b32 s54, s39, 10
    s_add_u32 s82, s54, 12713984
    s_lshl_b32 s54, s39, 7
    s_waitcnt vmcnt(6)
    s_barrier
    s_add_u32 s97, s43, 10
    s_and_b32 s97, s97, 15
    s_lshl_b32 s4, s97, 6
    s_add_u32 m0, s7, 32768
    s_add_u32 s5, s4, 15360
    buffer_load_dwordx4 v5, s[8:11], s4 offen lds
    buffer_load_dwordx4 v5, s[8:11], s5 offen offset:1024 lds
    s_add_u32 m0, s7, 49152
    s_add_u32 s4, s4, 64
    s_add_u32 s5, s5, 64
    buffer_load_dwordx4 v5, s[8:11], s4 offen lds
    buffer_load_dwordx4 v5, s[8:11], s5 offen offset:1024 lds
    s_add_u32 s97, s43, 11
    s_and_b32 s97, s97, 15
    s_mul_i32 s4, s97, 114688
    s_add_u32 m0, s7, 49152
    s_add_u32 s5, s4, 56320
    buffer_load_dwordx4 v7, s[12:15], s4 offen offset:2048 lds
    buffer_load_dwordx4 v7, s[12:15], s5 offen offset:3072 lds
    s_lshr_b32 s53, s39, 4
    s_lshl3_add_u32 s53, s53, s40
    s_lshl_b32 s53, s53, 11
    s_add_u32 s83, s53, 12845056
    s_lshl_b32 s53, s40, 18
    s_add_u32 s53, s53, s54
    s_lshl_b32 s54, s33, 16
    s_add_u32 s53, s53, s54
    s_add_u32 s81, s53, 2097152
    s_lshl2_add_u32 s53, s39, s33
    s_lshl_b32 s53, s53, 7
    s_add_u32 s89, s53, 12582916
    s_lshl_b32 s53, s33, 14
    s_add_u32 s53, s53, 0
    v_add_u32 v98, s53, v15
    s_xor_b32 s53, s33, 1
    s_lshl_b32 s53, s53, 14
    s_add_u32 s53, s53, 0
    v_add_u32 v99, s53, v15
    s_xor_b32 s53, s33, 3
    s_lshl_b32 s53, s53, 14
    s_add_u32 s53, s53, 0
    v_add_u32 v113, s53, v15
    s_waitcnt vmcnt(8)
    s_barrier
    s_add_u32 s97, s43, 12
    s_and_b32 s97, s97, 15
    s_mul_i32 s4, s97, 114688
    s_add_u32 m0, s7, 0
    s_add_u32 s5, s4, 56320
    buffer_load_dwordx4 v7, s[12:15], s4 offen offset:2048 lds
    buffer_load_dwordx4 v7, s[12:15], s5 offen offset:3072 lds
    s_lshl_b32 s53, s33, 14
    v_add_u32 v126, s53, v15
    v_add_u32 v100, 8192, v126
    v_add_u32 v101, 10240, v126
    v_lshrrev_b32 v102, 2, v3
    v_lshl_add_u32 v102, v4, 4, v102
    v_lshlrev_b32 v102, 7, v102
    v_and_b32 v126, 3, v3
    v_lshl_add_u32 v102, v126, 3, v102
    s_lshl_b32 s53, s33, 5
    s_add_u32 s53, s53, 66560
    v_add_u32 v102, s53, v102
    v_lshlrev_b32 v110, 7, v3
    v_lshl_add_u32 v110, v4, 5, v110
    s_lshl_b32 s53, s33, 11
    s_add_u32 s53, s53, 73744
    v_add_u32 v110, s53, v110
    s_lshl_b32 s53, s39, 16
    s_lshl_b32 s54, s40, 7
    s_add_u32 s55, s53, s54
    s_lshl_b32 s54, s33, 14
    s_add_u32 s53, s55, s54
    s_add_u32 s53, s53, 16
    v_lshlrev_b32 v103, 10, v3
    v_lshl_add_u32 v103, v4, 5, v103
    v_add_u32 v103, s53, v103
    s_waitcnt vmcnt(6)
    s_barrier
    s_add_u32 s97, s43, 12
    s_and_b32 s97, s97, 15
    s_lshl_b32 s4, s97, 6
    s_add_u32 m0, s7, 0
    s_add_u32 s5, s4, 15360
    buffer_load_dwordx4 v5, s[8:11], s4 offen lds
    buffer_load_dwordx4 v5, s[8:11], s5 offen offset:1024 lds
    s_add_u32 m0, s7, 16384
    s_add_u32 s4, s4, 64
    s_add_u32 s5, s5, 64
    buffer_load_dwordx4 v5, s[8:11], s4 offen lds
    buffer_load_dwordx4 v5, s[8:11], s5 offen offset:1024 lds
    s_add_u32 s97, s43, 13
    s_and_b32 s97, s97, 15
    s_mul_i32 s4, s97, 114688
    s_add_u32 m0, s7, 16384
    s_add_u32 s5, s4, 56320
    buffer_load_dwordx4 v7, s[12:15], s4 offen offset:2048 lds
    buffer_load_dwordx4 v7, s[12:15], s5 offen offset:3072 lds
    s_mov_b32 s96, 0
L_chk1:
    v_readfirstlane_b32 s41, v124
    s_nop 0
    s_cmp_lg_u32 s41, 0
    s_cbranch_scc1 L_ok1
    s_sleep 1
    v_mov_b32 v125, 0
    buffer_load_dword v124, v125, s[28:31], 0 offen sc1
    s_waitcnt vmcnt(0)
    s_add_u32 s96, s96, 1
    s_cmp_lt_u32 s96, 0x20000
    s_cbranch_scc1 L_chk1
L_ok1:
    s_lshl_b32 s54, s33, 14
    s_add_u32 s59, s55, s54
    v_lshrrev_b32 v104, 3, v0
    v_and_b32 v126, 7, v0
    v_lshlrev_b32 v126, 4, v126
    v_lshl_add_u32 v105, v104, 10, v126
    v_lshl_add_u32 v104, v104, 12, v126
    s_waitcnt vmcnt(8)
    s_barrier
    s_add_u32 s97, s43, 14
    s_and_b32 s97, s97, 15
    s_mul_i32 s4, s97, 114688
    s_add_u32 m0, s7, 32768
    s_add_u32 s5, s4, 56320
    buffer_load_dwordx4 v7, s[12:15], s4 offen offset:2048 lds
    buffer_load_dwordx4 v7, s[12:15], s5 offen offset:3072 lds
    s_cmp_lg_u32 s33, 0
    s_cbranch_scc1 L_nopoll
    s_mov_b32 s6, 12648448
    buffer_load_dwordx4 v[48:51], v97, s[16:19], s6 offen sc1
L_nopoll:
    s_waitcnt lgkmcnt(0)
    s_waitcnt vmcnt(6)
    s_barrier
    s_add_u32 s97, s43, 14
    s_and_b32 s97, s97, 15
    s_lshl_b32 s4, s97, 6
    s_add_u32 m0, s7, 32768
    s_add_u32 s5, s4, 15360
    buffer_load_dwordx4 v5, s[8:11], s4 offen lds
    buffer_load_dwordx4 v5, s[8:11], s5 offen offset:1024 lds
    s_add_u32 m0, s7, 49152
    s_add_u32 s4, s4, 64
    s_add_u32 s5, s5, 64
    buffer_load_dwordx4 v5, s[8:11], s4 offen lds
    buffer_load_dwordx4 v5, s[8:11], s5 offen offset:1024 lds
    s_add_u32 s97, s43, 15
    s_and_b32 s97, s97, 15
    s_mul_i32 s4, s97, 114688
    s_add_u32 m0, s7, 49152
    s_add_u32 s5, s4, 56320
    buffer_load_dwordx4 v7, s[12:15], s4 offen offset:2048 lds
    buffer_load_dwordx4 v7, s[12:15], s5 offen offset:3072 lds
    s_cmp_lg_u32 s33, 0
    s_cbranch_scc1 L_nopoll2
    buffer_load_dwordx4 v[52:55], v97, s[16:19], s6 offen sc1
L_nopoll2:
    ds_read_b128 a[0:3], v14 offset:0
    ds_read_b128 a[4:7], v13 offset:16384
    ds_read_b128 a[8:11], v13 offset:24576
    ds_read_b128 a[12:15], v122 offset:0
    ds_read_b128 a[16:19], v12 offset:16384
    ds_read_b128 a[20:23], v12 offset:24576
    ds_read_b128 a[24:27], v14 offset:128
    ds_read_b128 a[28:31], v13 offset:16512
    ds_read_b128 a[32:35], v13 offset:24704
    ds_read_b128 a[36:39], v122 offset:128
    ds_read_b128 a[40:43], v12 offset:16512
    ds_read_b128 a[44:47], v12 offset:24704
    s_cmp_lg_u32 s33, 0
    s_cbranch_scc1 L_nochk
    s_waitcnt vmcnt(7)
    v_xor_b32 v65, s41, v48
    v_xor_b32 v49, s41, v49
    v_or_b32 v65, v65, v49
    v_xor_b32 v50, s41, v50
    v_or_b32 v65, v65, v50
    v_xor_b32 v51, s41, v51
    v_or_b32 v65, v65, v51
    v_cmp_ne_u32 vcc, 0, v65
    s_nop 0
    s_cmp_eq_u64 vcc, 0
    s_cbranch_scc1 L_ok2
    s_mov_b32 s96, 0
L_chk2:
    buffer_load_dwordx4 v[48:51], v97, s[16:19], s6 offen sc1
    s_waitcnt vmcnt(1)
    v_xor_b32 v65, s41, v52
    v_xor_b32 v53, s41, v53
    v_or_b32 v65, v65, v53
    v_xor_b32 v54, s41, v54
    v_or_b32 v65, v65, v54
    v_xor_b32 v55, s41, v55
    v_or_b32 v65, v65, v55
    v_cmp_ne_u32 vcc, 0, v65
    s_nop 0
    s_cmp_eq_u64 vcc, 0
    s_cbranch_scc1 L_ok2
    buffer_load_dwordx4 v[52:55], v97, s[16:19], s6 offen sc1
    s_waitcnt vmcnt(1)
    v_xor_b32 v65, s41, v48
    v_xor_b32 v49, s41, v49
    v_or_b32 v65, v65, v49
    v_xor_b32 v50, s41, v50
    v_or_b32 v65, v65, v50
    v_xor_b32 v51, s41, v51
    v_or_b32 v65, v65, v51
    v_cmp_ne_u32 vcc, 0, v65
    s_nop 0
    s_cmp_eq_u64 vcc, 0
    s_cbranch_scc1 L_ok2
    s_add_u32 s96, s96, 1
    s_cmp_lt_u32 s96, 0x20000
    s_cbranch_scc1 L_chk2
L_ok2:
L_nochk:
    s_waitcnt vmcnt(8)
    s_barrier
    s_mov_b32 m0, s76
    s_lshl_b32 s4, s33, 4
    buffer_load_dwordx4 v106, s[20:23], s77 offen sc1 lds
    s_add_u32 m0, s76, 4096
    s_lshl_b64 s[96:97], 0xffff, s4
    buffer_load_dwordx4 v107, s[20:23], s77 offen sc1 lds
    s_mov_b32 m0, 145696
    s_mov_b64 exec, s[96:97]
    buffer_load_dwordx4 v108, s[20:23], s77 offen sc1 lds
    s_mov_b64 exec, -1
    s_add_u32 s4, s78, 229376
    buffer_load_dwordx4 a[64:67], v15, s[16:19], s4 offen offset:0 sc1
    buffer_load_dwordx4 a[68:71], v15, s[16:19], s4 offen offset:1024 sc1
    buffer_load_dwordx4 a[72:75], v15, s[16:19], s4 offen offset:2048 sc1
    buffer_load_dwordx4 a[76:79], v15, s[16:19], s4 offen offset:3072 sc1
    s_add_u32 s4, s78, 262144
    buffer_load_dwordx4 a[80:83], v15, s[16:19], s4 offen offset:0 sc1
    buffer_load_dwordx4 a[84:87], v15, s[16:19], s4 offen offset:1024 sc1
    buffer_load_dwordx4 a[88:91], v15, s[16:19], s4 offen offset:2048 sc1
    buffer_load_dwordx4 a[92:95], v15, s[16:19], s4 offen offset:3072 sc1
    s_waitcnt lgkmcnt(9)
    v_mfma_f32_16x16x32_bf16 v[16:19], a[4:7], a[0:3], 0
    v_mfma_f32_16x16x32_bf16 v[20:23], a[8:11], a[0:3], 0
    s_waitcnt lgkmcnt(6)
    v_mfma_f32_16x16x32_bf16 v[16:19], a[16:19], a[12:15], v[16:19]
    v_mfma_f32_16x16x32_bf16 v[20:23], a[20:23], a[12:15], v[20:23]
    s_waitcnt lgkmcnt(3)
    v_mfma_f32_16x16x32_bf16 v[16:19], a[28:31], a[24:27], v[16:19]
    v_mfma_f32_16x16x32_bf16 v[20:23], a[32:35], a[24:27], v[20:23]
    s_waitcnt lgkmcnt(0)
    v_mfma_f32_16x16x32_bf16 v[16:19], a[40:43], a[36:39], v[16:19]
    v_mfma_f32_16x16x32_bf16 v[20:23], a[44:47], a[36:39], v[20:23]
    ds_read_b128 a[0:3], v14 offset:256
    ds_read_b128 a[4:7], v13 offset:16640
    ds_read_b128 a[8:11], v13 offset:24832
    ds_read_b128 a[12:15], v122 offset:256
    ds_read_b128 a[16:19], v12 offset:16640
    ds_read_b128 a[20:23], v12 offset:24832
    ds_read_b128 a[24:27], v14 offset:384
    ds_read_b128 a[28:31], v13 offset:16768
    ds_read_b128 a[32:35], v13 offset:24960
    ds_read_b128 a[36:39], v122 offset:384
    ds_read_b128 a[40:43], v12 offset:16768
    ds_read_b128 a[44:47], v12 offset:24960
    s_waitcnt vmcnt(15)
    s_barrier
    s_add_u32 s4, s78, 294912
    buffer_load_dwordx4 a[96:99], v15, s[16:19], s4 offen offset:0 sc1
    buffer_load_dwordx4 a[100:103], v15, s[16:19], s4 offen offset:1024 sc1
    buffer_load_dwordx4 a[104:107], v15, s[16:19], s4 offen offset:2048 sc1
    buffer_load_dwordx4 a[108:111], v15, s[16:19], s4 offen offset:3072 sc1
    s_add_u32 s4, s78, 360448
    buffer_load_dwordx4 a[112:115], v15, s[16:19], s4 offen offset:0 sc1
    buffer_load_dwordx4 a[116:119], v15, s[16:19], s4 offen offset:1024 sc1
    buffer_load_dwordx4 a[120:123], v15, s[16:19], s4 offen offset:2048 sc1
    buffer_load_dwordx4 a[124:127], v15, s[16:19], s4 offen offset:3072 sc1
    s_waitcnt lgkmcnt(9)
    v_mfma_f32_16x16x32_bf16 v[16:19], a[4:7], a[0:3], v[16:19]
    v_mfma_f32_16x16x32_bf16 v[20:23], a[8:11], a[0:3], v[20:23]
    s_waitcnt lgkmcnt(6)
    v_mfma_f32_16x16x32_bf16 v[16:19], a[16:19], a[12:15], v[16:19]
    v_mfma_f32_16x16x32_bf16 v[20:23], a[20:23], a[12:15], v[20:23]
    s_waitcnt vmcnt(19)
    s_barrier
    s_add_u32 s4, s78, 393216
    buffer_load_dwordx4 v[48:51], v15, s[16:19], s4 offen offset:0 sc1
    buffer_load_dwordx4 v[52:55], v15, s[16:19], s4 offen offset:1024 sc1
    buffer_load_dwordx4 v[56:59], v15, s[16:19], s4 offen offset:2048 sc1
    buffer_load_dwordx4 v[60:63], v15, s[16:19], s4 offen offset:3072 sc1
    s_waitcnt lgkmcnt(3)
    v_mfma_f32_16x16x32_bf16 v[16:19], a[28:31], a[24:27], v[16:19]
    v_mfma_f32_16x16x32_bf16 v[20:23], a[32:35], a[24:27], v[20:23]
    s_waitcnt lgkmcnt(0)
    v_mfma_f32_16x16x32_bf16 v[16:19], a[40:43], a[36:39], v[16:19]
    v_mfma_f32_16x16x32_bf16 v[20:23], a[44:47], a[36:39], v[20:23]
    s_nop 6
    ds_write_b64 v88, v[16:17]
    ds_write_b64 v89, v[18:19]
    ds_write_b32 v90, v20 offset:2048
    ds_write_b32 v90, v21 offset:2176
    ds_write_b32 v90, v22 offset:2304
    ds_write_b32 v90, v23 offset:2432
    s_waitcnt lgkmcnt(0)
    s_barrier
    s_mov_b64 exec, s[94:95]
    ds_read_b32 v35, v66
    ds_read_b32 v34, v67
    ds_read_b32 v33, v68
    ds_read_b32 v32, v69
    ds_read_b32 v31, v70
    ds_read_b32 v30, v71
    ds_read_b32 v29, v72
    ds_read_b32 v28, v73
    ds_read_b32 v27, v74
    ds_read_b32 v26, v75
    ds_read_b32 v25, v76
    s_not_b64 exec, s[94:95]
    s_cbranch_execz L_nodirect
    ds_read_b128 v[24:27], v85 offset:0
    ds_read_b128 v[28:31], v85 offset:16
    ds_read_b128 v[32:35], v85 offset:32
L_nodirect:
    s_mov_b64 exec, -1
    ds_read_b32 v36, v77 offset:28
    ds_read_b32 v37, v77 offset:24
    ds_read_b32 v38, v77 offset:20
    ds_read_b32 v39, v77 offset:16
    ds_read_b32 v40, v77 offset:12
    ds_read_b32 v41, v77 offset:8
    ds_read_b32 v42, v77 offset:4
    ds_read_b32 v43, v77 offset:0
    v_mov_b32 v44, 0
    v_mov_b32 v45, 0
    v_mov_b32 v46, 0
    v_mov_b32 v47, 0
    s_mov_b32 exec_lo, 0x7ffffff
    s_mov_b32 exec_hi, 0x7ffffff
    ds_write_b128 v87, v[44:47]
    ds_write_b128 v79, v[44:47]
    s_mov_b64 exec, -1
    s_waitcnt lgkmcnt(10)
    v_cvt_pk_bf16_f32 v16, v35, v34
    v_cvt_pk_bf16_f32 v17, v33, v32
    v_cvt_pk_bf16_f32 v18, v31, v30
    v_cvt_pk_bf16_f32 v19, v29, v28
    ds_write_b128 v86, v[16:19] offset:0
    v_cvt_pk_bf16_f32 v20, v34, v33
    v_cvt_pk_bf16_f32 v21, v32, v31
    v_cvt_pk_bf16_f32 v22, v30, v29
    v_cvt_pk_bf16_f32 v23, v28, v27
    ds_write_b128 v86, v[20:23] offset:2496
    v_cvt_pk_bf16_f32 v16, v33, v32
    v_cvt_pk_bf16_f32 v17, v31, v30
    v_cvt_pk_bf16_f32 v18, v29, v28
    v_cvt_pk_bf16_f32 v19, v27, v26
    ds_write_b128 v86, v[16:19] offset:4992
    v_cvt_pk_bf16_f32 v20, v32, v31
    v_cvt_pk_bf16_f32 v21, v30, v29
    v_cvt_pk_bf16_f32 v22, v28, v27
    v_cvt_pk_bf16_f32 v23, v26, v25
    ds_write_b128 v86, v[20:23] offset:7488
    s_waitcnt lgkmcnt(6)
    v_cvt_pk_bf16_f32 v36, v36, v37
    v_cvt_pk_bf16_f32 v37, v38, v39
    v_cvt_pk_bf16_f32 v38, v40, v41
    v_cvt_pk_bf16_f32 v39, v42, v43
    ds_write_b128 v78, v[36:39]
    s_waitcnt vmcnt(20) lgkmcnt(0)
    s_barrier
    ds_read_b64 a[0:1], v91 offset:32
    ds_read_b64 a[2:3], v91 offset:40
    ds_read_b64 a[4:5], v91 offset:0
    ds_read_b64 a[6:7], v91 offset:8
    ds_read_b128 a[32:35], v92 offset:0
    ds_read_b128 a[36:39], v92 offset:4608
    ds_read_b64 a[8:9], v91 offset:96
    ds_read_b64 a[10:11], v91 offset:104
    ds_read_b64 a[12:13], v91 offset:64
    ds_read_b64 a[14:15], v91 offset:72
    ds_read_b128 a[40:43], v92 offset:128
    ds_read_b128 a[44:47], v92 offset:4736
    ds_read_b64 a[16:17], v91 offset:160
    ds_read_b64 a[18:19], v91 offset:168
    ds_read_b64 a[20:21], v91 offset:128
    ds_read_b64 a[22:23], v91 offset:136
    s_waitcnt lgkmcnt(6)
    v_mfma_f32_16x16x32_bf16 v[24:27], a[0:3], a[32:35], 0
    ds_read_b128 a[48:51], v92 offset:288
    v_mfma_f32_16x16x32_bf16 v[28:31], a[4:7], a[32:35], 0
    ds_read_b128 a[52:55], v92 offset:4896
    v_mfma_f32_16x16x32_bf16 v[16:19], a[8:11], a[32:35], 0
    ds_read_b64 a[24:25], v91 offset:224
    v_mfma_f32_16x16x32_bf16 v[20:23], a[12:15], a[32:35], 0
    ds_read_b64 a[26:27], v91 offset:232
    v_mfma_f32_16x16x32_bf16 v[40:43], a[0:3], a[36:39], 0
    ds_read_b64 a[28:29], v91 offset:192
    v_mfma_f32_16x16x32_bf16 v[44:47], a[4:7], a[36:39], 0
    ds_read_b64 a[30:31], v91 offset:200
    v_mfma_f32_16x16x32_bf16 v[32:35], a[8:11], a[36:39], 0
    v_mfma_f32_16x16x32_bf16 v[36:39], a[12:15], a[36:39], 0
    s_waitcnt lgkmcnt(6)
    v_mfma_f32_16x16x32_bf16 v[24:27], a[8:11], a[40:43], v[24:27]
    ds_read_b128 a[56:59], v92 offset:416
    v_mfma_f32_16x16x32_bf16 v[28:31], a[12:15], a[40:43], v[28:31]
    ds_read_b128 a[60:63], v92 offset:5024
    v_mfma_f32_16x16x32_bf16 v[16:19], a[16:19], a[40:43], v[16:19]
    ds_read_b64 a[0:1], v91 offset:288
    v_mfma_f32_16x16x32_bf16 v[20:23], a[20:23], a[40:43], v[20:23]
    ds_read_b64 a[2:3], v91 offset:296
    v_mfma_f32_16x16x32_bf16 v[40:43], a[8:11], a[44:47], v[40:43]
    ds_read_b64 a[4:5], v91 offset:256
    v_mfma_f32_16x16x32_bf16 v[44:47], a[12:15], a[44:47], v[44:47]
    ds_read_b64 a[6:7], v91 offset:264
    v_mfma_f32_16x16x32_bf16 v[32:35], a[16:19], a[44:47], v[32:35]
    v_mfma_f32_16x16x32_bf16 v[36:39], a[20:23], a[44:47], v[36:39]
    s_waitcnt lgkmcnt(6)
    v_mfma_f32_16x16x32_bf16 v[24:27], a[16:19], a[48:51], v[24:27]
    ds_read_b128 a[32:35], v92 offset:576
    v_mfma_f32_16x16x32_bf16 v[28:31], a[20:23], a[48:51], v[28:31]
    ds_read_b128 a[36:39], v92 offset:5184
    v_mfma_f32_16x16x32_bf16 v[16:19], a[24:27], a[48:51], v[16:19]
    ds_read_b64 a[8:9], v91 offset:352
    v_mfma_f32_16x16x32_bf16 v[20:23], a[28:31], a[48:51], v[20:23]
    ds_read_b64 a[10:11], v91 offset:360
    v_mfma_f32_16x16x32_bf16 v[40:43], a[16:19], a[52:55], v[40:43]
    ds_read_b64 a[12:13], v91 offset:320
    v_mfma_f32_16x16x32_bf16 v[44:47], a[20:23], a[52:55], v[44:47]
    ds_read_b64 a[14:15], v91 offset:328
    v_mfma_f32_16x16x32_bf16 v[32:35], a[24:27], a[52:55], v[32:35]
    v_mfma_f32_16x16x32_bf16 v[36:39], a[28:31], a[52:55], v[36:39]
    s_waitcnt lgkmcnt(6)
    v_mfma_f32_16x16x32_bf16 v[24:27], a[24:27], a[56:59], v[24:27]
    ds_read_b128 a[40:43], v92 offset:704
    v_mfma_f32_16x16x32_bf16 v[28:31], a[28:31], a[56:59], v[28:31]
    ds_read_b128 a[44:47], v92 offset:5312
    v_mfma_f32_16x16x32_bf16 v[16:19], a[0:3], a[56:59], v[16:19]
    ds_read_b64 a[16:17], v91 offset:416
    v_mfma_f32_16x16x32_bf16 v[20:23], a[4:7], a[56:59], v[20:23]
    ds_read_b64 a[18:19], v91 offset:424
    v_mfma_f32_16x16x32_bf16 v[40:43], a[24:27], a[60:63], v[40:43]
    ds_read_b64 a[20:21], v91 offset:384
    v_mfma_f32_16x16x32_bf16 v[44:47], a[28:31], a[60:63], v[44:47]
    ds_read_b64 a[22:23], v91 offset:392
    v_mfma_f32_16x16x32_bf16 v[32:35], a[0:3], a[60:63], v[32:35]
    v_mfma_f32_16x16x32_bf16 v[36:39], a[4:7], a[60:63], v[36:39]
    s_waitcnt lgkmcnt(6)
    v_mfma_f32_16x16x32_bf16 v[24:27], a[0:3], a[32:35], v[24:27]
    ds_read_b128 a[48:51], v92 offset:864
    v_mfma_f32_16x16x32_bf16 v[28:31], a[4:7], a[32:35], v[28:31]
    ds_read_b128 a[52:55], v92 offset:5472
    v_mfma_f32_16x16x32_bf16 v[16:19], a[8:11], a[32:35], v[16:19]
    ds_read_b64 a[24:25], v91 offset:480
    v_mfma_f32_16x16x32_bf16 v[20:23], a[12:15], a[32:35], v[20:23]
    ds_read_b64 a[26:27], v91 offset:488
    v_mfma_f32_16x16x32_bf16 v[40:43], a[0:3], a[36:39], v[40:43]
    ds_read_b64 a[28:29], v91 offset:448
    v_mfma_f32_16x16x32_bf16 v[44:47], a[4:7], a[36:39], v[44:47]
    ds_read_b64 a[30:31], v91 offset:456
    v_mfma_f32_16x16x32_bf16 v[32:35], a[8:11], a[36:39], v[32:35]
    v_mfma_f32_16x16x32_bf16 v[36:39], a[12:15], a[36:39], v[36:39]
    s_waitcnt lgkmcnt(6)
    v_mfma_f32_16x16x32_bf16 v[24:27], a[8:11], a[40:43], v[24:27]
    ds_read_b128 a[56:59], v92 offset:992
    v_mfma_f32_16x16x32_bf16 v[28:31], a[12:15], a[40:43], v[28:31]
    ds_read_b128 a[60:63], v92 offset:5600
    v_mfma_f32_16x16x32_bf16 v[16:19], a[16:19], a[40:43], v[16:19]
    ds_read_b64 a[0:1], v91 offset:544
    v_mfma_f32_16x16x32_bf16 v[20:23], a[20:23], a[40:43], v[20:23]
    ds_read_b64 a[2:3], v91 offset:552
    v_mfma_f32_16x16x32_bf16 v[40:43], a[8:11], a[44:47], v[40:43]
    ds_read_b64 a[4:5], v91 offset:512
    v_mfma_f32_16x16x32_bf16 v[44:47], a[12:15], a[44:47], v[44:47]
    ds_read_b64 a[6:7], v91 offset:520
    v_mfma_f32_16x16x32_bf16 v[32:35], a[16:19], a[44:47], v[32:35]
    v_mfma_f32_16x16x32_bf16 v[36:39], a[20:23], a[44:47], v[36:39]
    s_waitcnt lgkmcnt(6)
    v_mfma_f32_16x16x32_bf16 v[24:27], a[16:19], a[48:51], v[24:27]
    ds_read_b128 a[32:35], v92 offset:1152
    v_mfma_f32_16x16x32_bf16 v[28:31], a[20:23], a[48:51], v[28:31]
    ds_read_b128 a[36:39], v92 offset:5760
    v_mfma_f32_16x16x32_bf16 v[16:19], a[24:27], a[48:51], v[16:19]
    ds_read_b64 a[8:9], v91 offset:608
    v_mfma_f32_16x16x32_bf16 v[20:23], a[28:31], a[48:51], v[20:23]
    ds_read_b64 a[10:11], v91 offset:616
    v_mfma_f32_16x16x32_bf16 v[40:43], a[16:19], a[52:55], v[40:43]
    ds_read_b64 a[12:13], v91 offset:576
    v_mfma_f32_16x16x32_bf16 v[44:47], a[20:23], a[52:55], v[44:47]
    ds_read_b64 a[14:15], v91 offset:584
    v_mfma_f32_16x16x32_bf16 v[32:35], a[24:27], a[52:55], v[32:35]
    v_mfma_f32_16x16x32_bf16 v[36:39], a[28:31], a[52:55], v[36:39]
    s_waitcnt lgkmcnt(6)
    v_mfma_f32_16x16x32_bf16 v[24:27], a[24:27], a[56:59], v[24:27]
    ds_read_b128 a[40:43], v92 offset:1280
    v_mfma_f32_16x16x32_bf16 v[28:31], a[28:31], a[56:59], v[28:31]
    ds_read_b128 a[44:47], v92 offset:5888
    v_mfma_f32_16x16x32_bf16 v[16:19], a[0:3], a[56:59], v[16:19]
    ds_read_b64 a[16:17], v91 offset:672
    v_mfma_f32_16x16x32_bf16 v[20:23], a[4:7], a[56:59], v[20:23]
    ds_read_b64 a[18:19], v91 offset:680
    v_mfma_f32_16x16x32_bf16 v[40:43], a[24:27], a[60:63], v[40:43]
    ds_read_b64 a[20:21], v91 offset:640
    v_mfma_f32_16x16x32_bf16 v[44:47], a[28:31], a[60:63], v[44:47]
    ds_read_b64 a[22:23], v91 offset:648
    v_mfma_f32_16x16x32_bf16 v[32:35], a[0:3], a[60:63], v[32:35]
    v_mfma_f32_16x16x32_bf16 v[36:39], a[4:7], a[60:63], v[36:39]
    s_waitcnt lgkmcnt(6)
    v_mfma_f32_16x16x32_bf16 v[24:27], a[0:3], a[32:35], v[24:27]
    ds_read_b128 a[48:51], v92 offset:1440
    v_mfma_f32_16x16x32_bf16 v[28:31], a[4:7], a[32:35], v[28:31]
    ds_read_b128 a[52:55], v92 offset:6048
    v_mfma_f32_16x16x32_bf16 v[16:19], a[8:11], a[32:35], v[16:19]
    ds_read_b64 a[24:25], v91 offset:736
    v_mfma_f32_16x16x32_bf16 v[20:23], a[12:15], a[32:35], v[20:23]
    ds_read_b64 a[26:27], v91 offset:744
    v_mfma_f32_16x16x32_bf16 v[40:43], a[0:3], a[36:39], v[40:43]
    ds_read_b64 a[28:29], v91 offset:704
    v_mfma_f32_16x16x32_bf16 v[44:47], a[4:7], a[36:39], v[44:47]
    ds_read_b64 a[30:31], v91 offset:712
    v_mfma_f32_16x16x32_bf16 v[32:35], a[8:11], a[36:39], v[32:35]
    v_mfma_f32_16x16x32_bf16 v[36:39], a[12:15], a[36:39], v[36:39]
    s_barrier
    s_waitcnt lgkmcnt(6)
    v_mfma_f32_16x16x32_bf16 v[24:27], a[8:11], a[40:43], v[24:27]
    ds_read_b128 a[56:59], v92 offset:1568
    v_mfma_f32_16x16x32_bf16 v[28:31], a[12:15], a[40:43], v[28:31]
    ds_read_b128 a[60:63], v92 offset:6176
    v_mfma_f32_16x16x32_bf16 v[16:19], a[16:19], a[40:43], v[16:19]
    ds_read_b64 a[0:1], v91 offset:800
    v_mfma_f32_16x16x32_bf16 v[20:23], a[20:23], a[40:43], v[20:23]
    ds_read_b64 a[2:3], v91 offset:808
    v_mfma_f32_16x16x32_bf16 v[40:43], a[8:11], a[44:47], v[40:43]
    ds_read_b64 a[4:5], v91 offset:768
    v_mfma_f32_16x16x32_bf16 v[44:47], a[12:15], a[44:47], v[44:47]
    ds_read_b64 a[6:7], v91 offset:776
    v_mfma_f32_16x16x32_bf16 v[32:35], a[16:19], a[44:47], v[32:35]
    v_mfma_f32_16x16x32_bf16 v[36:39], a[20:23], a[44:47], v[36:39]
    s_waitcnt lgkmcnt(6)
    v_mfma_f32_16x16x32_bf16 v[24:27], a[16:19], a[48:51], v[24:27]
    ds_read_b128 a[32:35], v92 offset:1728
    v_mfma_f32_16x16x32_bf16 v[28:31], a[20:23], a[48:51], v[28:31]
    ds_read_b128 a[36:39], v92 offset:6336
    v_mfma_f32_16x16x32_bf16 v[16:19], a[24:27], a[48:51], v[16:19]
    ds_read_b64 a[8:9], v91 offset:864
    v_mfma_f32_16x16x32_bf16 v[20:23], a[28:31], a[48:51], v[20:23]
    ds_read_b64 a[10:11], v91 offset:872
    v_mfma_f32_16x16x32_bf16 v[40:43], a[16:19], a[52:55], v[40:43]
    ds_read_b64 a[12:13], v91 offset:832
    v_mfma_f32_16x16x32_bf16 v[44:47], a[20:23], a[52:55], v[44:47]
    ds_read_b64 a[14:15], v91 offset:840
    v_mfma_f32_16x16x32_bf16 v[32:35], a[24:27], a[52:55], v[32:35]
    v_mfma_f32_16x16x32_bf16 v[36:39], a[28:31], a[52:55], v[36:39]
    s_waitcnt lgkmcnt(6)
    v_mfma_f32_16x16x32_bf16 v[24:27], a[24:27], a[56:59], v[24:27]
    ds_read_b128 a[40:43], v92 offset:1856
    v_mfma_f32_16x16x32_bf16 v[28:31], a[28:31], a[56:59], v[28:31]
    ds_read_b128 a[44:47], v92 offset:6464
    v_mfma_f32_16x16x32_bf16 v[16:19], a[0:3], a[56:59], v[16:19]
    ds_read_b64 a[16:17], v91 offset:928
    v_mfma_f32_16x16x32_bf16 v[20:23], a[4:7], a[56:59], v[20:23]
    ds_read_b64 a[18:19], v91 offset:936
    v_mfma_f32_16x16x32_bf16 v[40:43], a[24:27], a[60:63], v[40:43]
    ds_read_b64 a[20:21], v91 offset:896
    v_mfma_f32_16x16x32_bf16 v[44:47], a[28:31], a[60:63], v[44:47]
    ds_read_b64 a[22:23], v91 offset:904
    v_mfma_f32_16x16x32_bf16 v[32:35], a[0:3], a[60:63], v[32:35]
    v_mfma_f32_16x16x32_bf16 v[36:39], a[4:7], a[60:63], v[36:39]
    s_waitcnt lgkmcnt(6)
    v_mfma_f32_16x16x32_bf16 v[24:27], a[0:3], a[32:35], v[24:27]
    ds_read_b128 a[48:51], v92 offset:2016
    v_mfma_f32_16x16x32_bf16 v[28:31], a[4:7], a[32:35], v[28:31]
    ds_read_b128 a[52:55], v92 offset:6624
    v_mfma_f32_16x16x32_bf16 v[16:19], a[8:11], a[32:35], v[16:19]
    ds_read_b64 a[24:25], v91 offset:992
    v_mfma_f32_16x16x32_bf16 v[20:23], a[12:15], a[32:35], v[20:23]
    ds_read_b64 a[26:27], v91 offset:1000
    v_mfma_f32_16x16x32_bf16 v[40:43], a[0:3], a[36:39], v[40:43]
    ds_read_b64 a[28:29], v91 offset:960
    v_mfma_f32_16x16x32_bf16 v[44:47], a[4:7], a[36:39], v[44:47]
    ds_read_b64 a[30:31], v91 offset:968
    v_mfma_f32_16x16x32_bf16 v[32:35], a[8:11], a[36:39], v[32:35]
    v_mfma_f32_16x16x32_bf16 v[36:39], a[12:15], a[36:39], v[36:39]
    s_waitcnt lgkmcnt(6)
    v_mfma_f32_16x16x32_bf16 v[24:27], a[8:11], a[40:43], v[24:27]
    ds_read_b128 a[56:59], v92 offset:2144
    v_mfma_f32_16x16x32_bf16 v[28:31], a[12:15], a[40:43], v[28:31]
    ds_read_b128 a[60:63], v92 offset:6752
    v_mfma_f32_16x16x32_bf16 v[16:19], a[16:19], a[40:43], v[16:19]
    ds_read_b64 a[0:1], v91 offset:1056
    v_mfma_f32_16x16x32_bf16 v[20:23], a[20:23], a[40:43], v[20:23]
    ds_read_b64 a[2:3], v91 offset:1064
    v_mfma_f32_16x16x32_bf16 v[40:43], a[8:11], a[44:47], v[40:43]
    ds_read_b64 a[4:5], v91 offset:1024
    v_mfma_f32_16x16x32_bf16 v[44:47], a[12:15], a[44:47], v[44:47]
    ds_read_b64 a[6:7], v91 offset:1032
    v_mfma_f32_16x16x32_bf16 v[32:35], a[16:19], a[44:47], v[32:35]
    v_mfma_f32_16x16x32_bf16 v[36:39], a[20:23], a[44:47], v[36:39]
    s_waitcnt lgkmcnt(6)
    v_mfma_f32_16x16x32_bf16 v[24:27], a[16:19], a[48:51], v[24:27]
    ds_read_b128 a[32:35], v92 offset:2304
    v_mfma_f32_16x16x32_bf16 v[28:31], a[20:23], a[48:51], v[28:31]
    ds_read_b128 a[36:39], v92 offset:6912
    v_mfma_f32_16x16x32_bf16 v[16:19], a[24:27], a[48:51], v[16:19]
    ds_read_b64 a[8:9], v91 offset:1120
    v_mfma_f32_16x16x32_bf16 v[20:23], a[28:31], a[48:51], v[20:23]
    ds_read_b64 a[10:11], v91 offset:1128
    v_mfma_f32_16x16x32_bf16 v[40:43], a[16:19], a[52:55], v[40:43]
    ds_read_b64 a[12:13], v91 offset:1088
    v_mfma_f32_16x16x32_bf16 v[44:47], a[20:23], a[52:55], v[44:47]
    ds_read_b64 a[14:15], v91 offset:1096
    v_mfma_f32_16x16x32_bf16 v[32:35], a[24:27], a[52:55], v[32:35]
    v_mfma_f32_16x16x32_bf16 v[36:39], a[28:31], a[52:55], v[36:39]
    s_waitcnt lgkmcnt(6)
    v_mfma_f32_16x16x32_bf16 v[24:27], a[24:27], a[56:59], v[24:27]
    ds_read_b128 a[40:43], v92 offset:2432
    ds_read_b128 a[44:47], v92 offset:7040
    v_mfma_f32_16x16x32_bf16 v[28:31], a[28:31], a[56:59], v[28:31]
    ds_read_b64 a[16:17], v91 offset:1184
    v_mfma_f32_16x16x32_bf16 v[16:19], a[0:3], a[56:59], v[16:19]
    ds_read_b64 a[18:19], v91 offset:1192
    v_mfma_f32_16x16x32_bf16 v[20:23], a[4:7], a[56:59], v[20:23]
    ds_read_b64 a[20:21], v91 offset:1152
    v_mfma_f32_16x16x32_bf16 v[40:43], a[24:27], a[60:63], v[40:43]
    ds_read_b64 a[22:23], v91 offset:1160
    v_mfma_f32_16x16x32_bf16 v[44:47], a[28:31], a[60:63], v[44:47]
    ds_read_b64_tr_b16 v[68:69], v83 offset:0
    v_mfma_f32_16x16x32_bf16 v[32:35], a[0:3], a[60:63], v[32:35]
    ds_read_b64_tr_b16 v[70:71], v83 offset:128
    v_mfma_f32_16x16x32_bf16 v[36:39], a[4:7], a[60:63], v[36:39]
    s_waitcnt lgkmcnt(8)
    v_mfma_f32_16x16x32_bf16 v[24:27], a[0:3], a[32:35], v[24:27]
    ds_read_b64_tr_b16 v[72:73], v83 offset:2176
    v_mfma_f32_16x16x32_bf16 v[28:31], a[4:7], a[32:35], v[28:31]
    ds_read_b64_tr_b16 v[74:75], v83 offset:2304
    v_mfma_f32_16x16x32_bf16 v[16:19], a[8:11], a[32:35], v[16:19]
    v_mfma_f32_16x16x32_bf16 v[20:23], a[12:15], a[32:35], v[20:23]
    v_mfma_f32_16x16x32_bf16 v[40:43], a[0:3], a[36:39], v[40:43]
    v_mfma_f32_16x16x32_bf16 v[44:47], a[4:7], a[36:39], v[44:47]
    v_mfma_f32_16x16x32_bf16 v[32:35], a[8:11], a[36:39], v[32:35]
    v_mfma_f32_16x16x32_bf16 v[36:39], a[12:15], a[36:39], v[36:39]
    s_waitcnt lgkmcnt(4)
    v_mfma_f32_16x16x32_bf16 v[24:27], a[8:11], a[40:43], v[24:27]
    ds_read_b64 a[48:49], v84 offset:0
    ds_read_b64 a[50:51], v84 offset:8
    v_mfma_f32_16x16x32_bf16 v[28:31], a[12:15], a[40:43], v[28:31]
    ds_read_b64 a[52:53], v84 offset:256
    v_mfma_f32_16x16x32_bf16 v[16:19], a[16:19], a[40:43], v[16:19]
    ds_read_b64 a[54:55], v84 offset:264
    v_mfma_f32_16x16x32_bf16 v[20:23], a[20:23], a[40:43], v[20:23]
    ds_read_b64 a[56:57], v84 offset:512
    v_mfma_f32_16x16x32_bf16 v[40:43], a[8:11], a[44:47], v[40:43]
    ds_read_b64 a[58:59], v84 offset:520
    v_mfma_f32_16x16x32_bf16 v[44:47], a[12:15], a[44:47], v[44:47]
    ds_read_b64 a[60:61], v84 offset:768
    v_mfma_f32_16x16x32_bf16 v[32:35], a[16:19], a[44:47], v[32:35]
    ds_read_b64 a[62:63], v84 offset:776
    v_mfma_f32_16x16x32_bf16 v[36:39], a[20:23], a[44:47], v[36:39]
    ds_read_b64 a[0:1], v84 offset:1024
    ds_read_b64 a[2:3], v84 offset:1032
    ds_read_b64 a[4:5], v84 offset:1280
    ds_read_b64 a[6:7], v84 offset:1288
    ds_read_b64 a[8:9], v84 offset:1536
    ds_read_b64 a[10:11], v84 offset:1544
    ds_read_b64 a[12:13], v84 offset:1792
    ds_read_b64 a[14:15], v84 offset:1800
    ds_read_b64 v[76:77], v95 offset:0
    ds_read_b64 v[78:79], v95 offset:64
    ds_read_b64 v[80:81], v95 offset:128
    ds_read_b64 v[82:83], v95 offset:192
    s_waitcnt lgkmcnt(12)
    v_mfma_f32_16x16x32_bf16 v[32:35], v[68:71], a[48:51], v[32:35]
    v_mfma_f32_16x16x32_bf16 v[36:39], v[68:71], a[52:55], v[36:39]
    v_mfma_f32_16x16x32_bf16 v[40:43], v[68:71], a[56:59], v[40:43]
    v_mfma_f32_16x16x32_bf16 v[44:47], v[68:71], a[60:63], v[44:47]
    s_waitcnt lgkmcnt(4)
    v_mfma_f32_16x16x32_bf16 v[32:35], v[72:75], a[0:3], v[32:35]
    v_mfma_f32_16x16x32_bf16 v[36:39], v[72:75], a[4:7], v[36:39]
    v_mfma_f32_16x16x32_bf16 v[40:43], v[72:75], a[8:11], v[40:43]
    v_mfma_f32_16x16x32_bf16 v[44:47], v[72:75], a[12:15], v[44:47]
    s_cmp_eq_u32 s86, 1
    s_cbranch_scc1 L_keep1
    s_waitcnt lgkmcnt(0)
    v_lshlrev_b32 v64, 16, v76
    v_and_b32 v65, 0xffff0000, v76
    v_fmac_f32 v16, s88, v64
    v_fmac_f32 v17, s88, v65
    v_lshlrev_b32 v64, 16, v77
    v_and_b32 v65, 0xffff0000, v77
    v_fmac_f32 v18, s88, v64
    v_fmac_f32 v19, s88, v65
    v_lshlrev_b32 v64, 16, v78
    v_and_b32 v65, 0xffff0000, v78
    v_fmac_f32 v20, s88, v64
    v_fmac_f32 v21, s88, v65
    v_lshlrev_b32 v64, 16, v79
    v_and_b32 v65, 0xffff0000, v79
    v_fmac_f32 v22, s88, v64
    v_fmac_f32 v23, s88, v65
    v_lshlrev_b32 v64, 16, v80
    v_and_b32 v65, 0xffff0000, v80
    v_fmac_f32 v24, s88, v64
    v_fmac_f32 v25, s88, v65
    v_lshlrev_b32 v64, 16, v81
    v_and_b32 v65, 0xffff0000, v81
    v_fmac_f32 v26, s88, v64
    v_fmac_f32 v27, s88, v65
    v_lshlrev_b32 v64, 16, v82
    v_and_b32 v65, 0xffff0000, v82
    v_fmac_f32 v28, s88, v64
    v_fmac_f32 v29, s88, v65
    v_lshlrev_b32 v64, 16, v83
    v_and_b32 v65, 0xffff0000, v83
    v_fmac_f32 v30, s88, v64
    v_fmac_f32 v31, s88, v65
    ds_write_b128 v93, v[32:35] offset:0
    ds_write_b128 v93, v[36:39] offset:1024
    ds_write_b128 v93, v[40:43] offset:2048
    ds_write_b128 v93, v[44:47] offset:3072
    s_waitcnt lgkmcnt(0)
    s_barrier
    ds_read_b128 v[32:35], v94 offset:0
    ds_read_b128 v[36:39], v94 offset:1024
    ds_read_b128 v[40:43], v94 offset:2048
    ds_read_b128 v[44:47], v94 offset:3072
    s_waitcnt lgkmcnt(0)
    v_add_f32 v16, v16, v32
    v_add_f32 v17, v17, v33
    v_add_f32 v18, v18, v34
    v_add_f32 v19, v19, v35
    v_add_f32 v20, v20, v36
    v_add_f32 v21, v21, v37
    v_add_f32 v22, v22, v38
    v_add_f32 v23, v23, v39
    v_add_f32 v24, v24, v40
    v_add_f32 v25, v25, v41
    v_add_f32 v26, v26, v42
    v_add_f32 v27, v27, v43
    v_add_f32 v28, v28, v44
    v_add_f32 v29, v29, v45
    v_add_f32 v30, v30, v46
    v_add_f32 v31, v31, v47
    v_cvt_pk_bf16_f32 v76, v16, v17
    v_cvt_pk_bf16_f32 v77, v18, v19
    v_cvt_pk_bf16_f32 v78, v20, v21
    v_cvt_pk_bf16_f32 v79, v22, v23
    v_cvt_pk_bf16_f32 v80, v24, v25
    v_cvt_pk_bf16_f32 v81, v26, v27
    v_cvt_pk_bf16_f32 v82, v28, v29
    v_cvt_pk_bf16_f32 v83, v30, v31
    s_branch L_kept
L_keep1:
    s_waitcnt lgkmcnt(0)
    ds_write_b128 v93, v[16:19] offset:0
    ds_write_b128 v93, v[20:23] offset:1024
    ds_write_b128 v93, v[24:27] offset:2048
    ds_write_b128 v93, v[28:31] offset:3072
    v_lshlrev_b32 v64, 16, v76
    v_and_b32 v65, 0xffff0000, v76
    v_fmac_f32 v32, s88, v64
    v_fmac_f32 v33, s88, v65
    v_lshlrev_b32 v64, 16, v77
    v_and_b32 v65, 0xffff0000, v77
    v_fmac_f32 v34, s88, v64
    v_fmac_f32 v35, s88, v65
    v_lshlrev_b32 v64, 16, v78
    v_and_b32 v65, 0xffff0000, v78
    v_fmac_f32 v36, s88, v64
    v_fmac_f32 v37, s88, v65
    v_lshlrev_b32 v64, 16, v79
    v_and_b32 v65, 0xffff0000, v79
    v_fmac_f32 v38, s88, v64
    v_fmac_f32 v39, s88, v65
    v_lshlrev_b32 v64, 16, v80
    v_and_b32 v65, 0xffff0000, v80
    v_fmac_f32 v40, s88, v64
    v_fmac_f32 v41, s88, v65
    v_lshlrev_b32 v64, 16, v81
    v_and_b32 v65, 0xffff0000, v81
    v_fmac_f32 v42, s88, v64
    v_fmac_f32 v43, s88, v65
    v_lshlrev_b32 v64, 16, v82
    v_and_b32 v65, 0xffff0000, v82
    v_fmac_f32 v44, s88, v64
    v_fmac_f32 v45, s88, v65
    v_lshlrev_b32 v64, 16, v83
    v_and_b32 v65, 0xffff0000, v83
    v_fmac_f32 v46, s88, v64
    v_fmac_f32 v47, s88, v65
    s_waitcnt lgkmcnt(0)
    s_barrier
    ds_read_b128 v[16:19], v94 offset:0
    ds_read_b128 v[20:23], v94 offset:1024
    ds_read_b128 v[24:27], v94 offset:2048
    ds_read_b128 v[28:31], v94 offset:3072
    s_waitcnt lgkmcnt(0)
    v_add_f32 v32, v32, v16
    v_add_f32 v33, v33, v17
    v_add_f32 v34, v34, v18
    v_add_f32 v35, v35, v19
    v_add_f32 v36, v36, v20
    v_add_f32 v37, v37, v21
    v_add_f32 v38, v38, v22
    v_add_f32 v39, v39, v23
    v_add_f32 v40, v40, v24
    v_add_f32 v41, v41, v25
    v_add_f32 v42, v42, v26
    v_add_f32 v43, v43, v27
    v_add_f32 v44, v44, v28
    v_add_f32 v45, v45, v29
    v_add_f32 v46, v46, v30
    v_add_f32 v47, v47, v31
    v_cvt_pk_bf16_f32 v76, v32, v33
    v_cvt_pk_bf16_f32 v77, v34, v35
    v_cvt_pk_bf16_f32 v78, v36, v37
    v_cvt_pk_bf16_f32 v79, v38, v39
    v_cvt_pk_bf16_f32 v80, v40, v41
    v_cvt_pk_bf16_f32 v81, v42, v43
    v_cvt_pk_bf16_f32 v82, v44, v45
    v_cvt_pk_bf16_f32 v83, v46, v47
L_kept:
    v_permlane16_swap_b32 v76, v78
    v_permlane16_swap_b32 v77, v79
    v_permlane16_swap_b32 v80, v82
    v_permlane16_swap_b32 v81, v83
    buffer_store_dwordx4 v[76:79], v96, s[16:19], s80 offen sc1
    buffer_store_dwordx4 v[80:83], v96, s[16:19], s80 offen offset:64 sc1
    s_barrier
    ds_read_b128 v[32:35], v109 offset:8192
    ds_read_b128 v[36:39], v109 offset:9216
    ds_read_b128 v[40:43], v109 offset:10240
    ds_read_b128 v[44:47], v109 offset:11264
    ds_read_b128 a[48:51], v109 offset:12288
    ds_read_b128 a[52:55], v109 offset:13312
    ds_read_b128 a[56:59], v109 offset:14336
    ds_read_b128 a[60:63], v109 offset:15360
    s_add_u32 s4, s70, 4096
    buffer_load_dwordx4 a[0:3], v15, s[16:19], s4 offen offset:3072 sc1
    s_add_u32 s4, s70, 8192
    buffer_load_dwordx4 a[4:7], v15, s[16:19], s4 offen offset:0 sc1
    buffer_load_dwordx4 a[8:11], v15, s[16:19], s4 offen offset:1024 sc1
    buffer_load_dwordx4 a[12:15], v15, s[16:19], s4 offen offset:3072 sc1
    s_add_u32 s4, s70, 12288
    buffer_load_dwordx4 a[16:19], v15, s[16:19], s4 offen offset:0 sc1
    buffer_load_dwordx4 a[20:23], v15, s[16:19], s4 offen offset:1024 sc1
    buffer_load_dwordx4 v[68:71], v15, s[16:19], s44 offen sc1
    buffer_load_dwordx4 v[72:75], v15, s[16:19], s45 offen sc1
    s_waitcnt lgkmcnt(0)
    s_waitcnt vmcnt(7)
    v_mfma_f32_16x16x32_bf16 v[16:19], a[64:67], a[0:3], 0
    v_mfma_f32_16x16x32_bf16 v[20:23], a[68:71], a[0:3], 0
    s_add_u32 s4, s71, 4096
    buffer_load_dwordx4 a[24:27], v15, s[16:19], s4 offen offset:3072 sc1
    v_mfma_f32_16x16x32_bf16 v[24:27], a[72:75], a[0:3], 0
    v_mfma_f32_16x16x32_bf16 v[28:31], a[76:79], a[0:3], 0
    s_add_u32 s4, s71, 8192
    buffer_load_dwordx4 a[28:31], v15, s[16:19], s4 offen offset:0 sc1
    s_waitcnt vmcnt(8)
    v_mfma_f32_16x16x32_bf16 v[16:19], a[80:83], a[4:7], v[16:19]
    v_mfma_f32_16x16x32_bf16 v[20:23], a[84:87], a[4:7], v[20:23]
    buffer_load_dwordx4 a[32:35], v15, s[16:19], s4 offen offset:1024 sc1
    v_mfma_f32_16x16x32_bf16 v[24:27], a[88:91], a[4:7], v[24:27]
    v_mfma_f32_16x16x32_bf16 v[28:31], a[92:95], a[4:7], v[28:31]
    buffer_load_dwordx4 a[36:39], v15, s[16:19], s4 offen offset:3072 sc1
    s_waitcnt vmcnt(9)
    v_mfma_f32_16x16x32_bf16 v[16:19], a[96:99], a[8:11], v[16:19]
    v_mfma_f32_16x16x32_bf16 v[20:23], a[100:103], a[8:11], v[20:23]
    s_add_u32 s4, s71, 12288
    buffer_load_dwordx4 a[40:43], v15, s[16:19], s4 offen offset:0 sc1
    v_mfma_f32_16x16x32_bf16 v[24:27], a[104:107], a[8:11], v[24:27]
    v_mfma_f32_16x16x32_bf16 v[28:31], a[108:111], a[8:11], v[28:31]
    buffer_load_dwordx4 a[44:47], v15, s[16:19], s4 offen offset:1024 sc1
    s_waitcnt vmcnt(10)
    v_mfma_f32_16x16x32_bf16 v[16:19], a[112:115], a[12:15], v[16:19]
    v_mfma_f32_16x16x32_bf16 v[20:23], a[116:119], a[12:15], v[20:23]
    v_mov_b32 v125, 0
    v_mov_b32 v126, s41
    s_mov_b64 exec, 1
    buffer_store_dword v126, v125, s[16:19], s93 offen sc1
    s_mov_b64 exec, -1
    v_mfma_f32_16x16x32_bf16 v[24:27], a[120:123], a[12:15], v[24:27]
    v_mfma_f32_16x16x32_bf16 v[28:31], a[124:127], a[12:15], v[28:31]
    s_waitcnt vmcnt(10)
    v_mfma_f32_16x16x32_bf16 v[16:19], v[48:51], a[16:19], v[16:19]
    v_mfma_f32_16x16x32_bf16 v[20:23], v[52:55], a[16:19], v[20:23]
    v_mfma_f32_16x16x32_bf16 v[24:27], v[56:59], a[16:19], v[24:27]
    v_mfma_f32_16x16x32_bf16 v[28:31], v[60:63], a[16:19], v[28:31]
    s_waitcnt vmcnt(9)
    v_mfma_f32_16x16x32_bf16 v[16:19], v[32:35], a[20:23], v[16:19]
    s_barrier
    v_mfma_f32_16x16x32_bf16 v[20:23], v[36:39], a[20:23], v[20:23]
    s_waitcnt vmcnt(7)
    s_cmp_eq_u32 s86, 1
    s_cbranch_scc1 L_sw3
    v_swap_b32 v68, v74
    v_swap_b32 v69, v75
    s_branch L_sx3
L_sw3:
    v_swap_b32 v70, v72
    v_swap_b32 v71, v73
L_sx3:
    v_mfma_f32_16x16x32_bf16 v[24:27], v[40:43], a[20:23], v[24:27]
    v_mfma_f32_16x16x32_bf16 v[28:31], v[44:47], a[20:23], v[28:31]
    v_mfma_f32_16x16x32_bf16 v[16:19], a[48:51], v[68:71], v[16:19]
    v_mfma_f32_16x16x32_bf16 v[20:23], a[52:55], v[68:71], v[20:23]
    v_mfma_f32_16x16x32_bf16 v[24:27], a[56:59], v[68:71], v[24:27]
    v_mfma_f32_16x16x32_bf16 v[28:31], a[60:63], v[68:71], v[28:31]
    s_nop 4
    ds_write_b128 v98, v[16:19] offset:0
    ds_write_b128 v98, v[20:23] offset:1024
    ds_write_b128 v98, v[24:27] offset:2048
    ds_write_b128 v98, v[28:31] offset:3072
    s_add_u32 s4, s72, 4096
    buffer_load_dwordx4 a[0:3], v15, s[16:19], s4 offen offset:3072 sc1
    s_waitcnt lgkmcnt(0)
    s_barrier
    ds_read_b128 v[16:19], v99 offset:0
    ds_read_b128 v[20:23], v99 offset:1024
    ds_read_b128 v[24:27], v99 offset:2048
    ds_read_b128 v[28:31], v99 offset:3072
    s_add_u32 s4, s72, 8192
    buffer_load_dwordx4 a[4:7], v15, s[16:19], s4 offen offset:0 sc1
    buffer_load_dwordx4 a[8:11], v15, s[16:19], s4 offen offset:1024 sc1
    buffer_load_dwordx4 a[12:15], v15, s[16:19], s4 offen offset:3072 sc1
    s_add_u32 s4, s72, 12288
    buffer_load_dwordx4 a[16:19], v15, s[16:19], s4 offen offset:0 sc1
    buffer_load_dwordx4 a[20:23], v15, s[16:19], s4 offen offset:1024 sc1
    buffer_load_dwordx4 v[76:79], v15, s[16:19], s46 offen sc1
    buffer_load_dwordx4 v[80:83], v15, s[16:19], s47 offen sc1
    s_waitcnt lgkmcnt(0)
    s_waitcnt vmcnt(14)
    v_mfma_f32_16x16x32_bf16 v[16:19], a[64:67], a[24:27], v[16:19]
    v_mfma_f32_16x16x32_bf16 v[20:23], a[68:71], a[24:27], v[20:23]
    v_mfma_f32_16x16x32_bf16 v[24:27], a[72:75], a[24:27], v[24:27]
    v_mfma_f32_16x16x32_bf16 v[28:31], a[76:79], a[24:27], v[28:31]
    s_waitcnt vmcnt(13)
    v_mfma_f32_16x16x32_bf16 v[16:19], a[80:83], a[28:31], v[16:19]
    v_mfma_f32_16x16x32_bf16 v[20:23], a[84:87], a[28:31], v[20:23]
    v_mfma_f32_16x16x32_bf16 v[24:27], a[88:91], a[28:31], v[24:27]
    v_mfma_f32_16x16x32_bf16 v[28:31], a[92:95], a[28:31], v[28:31]
    s_waitcnt vmcnt(12)
    v_mfma_f32_16x16x32_bf16 v[16:19], a[96:99], a[32:35], v[16:19]
    v_mfma_f32_16x16x32_bf16 v[20:23], a[100:103], a[32:35], v[20:23]
    v_mfma_f32_16x16x32_bf16 v[24:27], a[104:107], a[32:35], v[24:27]
    v_mfma_f32_16x16x32_bf16 v[28:31], a[108:111], a[32:35], v[28:31]
    s_waitcnt vmcnt(11)
    v_mfma_f32_16x16x32_bf16 v[16:19], a[112:115], a[36:39], v[16:19]
    v_mfma_f32_16x16x32_bf16 v[20:23], a[116:119], a[36:39], v[20:23]
    v_mfma_f32_16x16x32_bf16 v[24:27], a[120:123], a[36:39], v[24:27]
    v_mfma_f32_16x16x32_bf16 v[28:31], a[124:127], a[36:39], v[28:31]
    s_waitcnt vmcnt(10)
    v_mfma_f32_16x16x32_bf16 v[16:19], v[48:51], a[40:43], v[16:19]
    s_barrier
    v_mfma_f32_16x16x32_bf16 v[20:23], v[52:55], a[40:43], v[20:23]
    v_mfma_f32_16x16x32_bf16 v[24:27], v[56:59], a[40:43], v[24:27]
    v_mfma_f32_16x16x32_bf16 v[28:31], v[60:63], a[40:43], v[28:31]
    s_waitcnt vmcnt(9)
    v_mfma_f32_16x16x32_bf16 v[16:19], v[32:35], a[44:47], v[16:19]
    v_mfma_f32_16x16x32_bf16 v[20:23], v[36:39], a[44:47], v[20:23]
    v_mfma_f32_16x16x32_bf16 v[24:27], v[40:43], a[44:47], v[24:27]
    v_mfma_f32_16x16x32_bf16 v[28:31], v[44:47], a[44:47], v[28:31]
    v_mfma_f32_16x16x32_bf16 v[16:19], a[48:51], v[72:75], v[16:19]
    v_mfma_f32_16x16x32_bf16 v[20:23], a[52:55], v[72:75], v[20:23]
    v_mfma_f32_16x16x32_bf16 v[24:27], a[56:59], v[72:75], v[24:27]
    v_mfma_f32_16x16x32_bf16 v[28:31], a[60:63], v[72:75], v[28:31]
    s_nop 4
    ds_write_b128 v98, v[16:19] offset:4096
    ds_write_b128 v98, v[20:23] offset:5120
    ds_write_b128 v98, v[24:27] offset:6144
    ds_write_b128 v98, v[28:31] offset:7168
    s_add_u32 s4, s73, 4096
    buffer_load_dwordx4 a[24:27], v15, s[16:19], s4 offen offset:3072 sc1
    s_waitcnt lgkmcnt(0)
    s_barrier
    ds_read_b128 v[16:19], v113 offset:4096
    ds_read_b128 v[20:23], v113 offset:5120
    ds_read_b128 v[24:27], v113 offset:6144
    ds_read_b128 v[28:31], v113 offset:7168
    s_add_u32 s4, s73, 8192
    buffer_load_dwordx4 a[28:31], v15, s[16:19], s4 offen offset:0 sc1
    buffer_load_dwordx4 a[32:35], v15, s[16:19], s4 offen offset:1024 sc1
    buffer_load_dwordx4 a[36:39], v15, s[16:19], s4 offen offset:3072 sc1
    s_add_u32 s4, s73, 12288
    buffer_load_dwordx4 a[40:43], v15, s[16:19], s4 offen offset:0 sc1
    buffer_load_dwordx4 a[44:47], v15, s[16:19], s4 offen offset:1024 sc1
    v_lshlrev_b32 v126, 3, v3
    buffer_load_dword v14, v126, s[16:19], s89 offen sc1
    s_waitcnt lgkmcnt(0)
    s_waitcnt vmcnt(14)
    v_mfma_f32_16x16x32_bf16 v[16:19], a[64:67], a[0:3], v[16:19]
    v_mfma_f32_16x16x32_bf16 v[20:23], a[68:71], a[0:3], v[20:23]
    v_mfma_f32_16x16x32_bf16 v[24:27], a[72:75], a[0:3], v[24:27]
    v_mfma_f32_16x16x32_bf16 v[28:31], a[76:79], a[0:3], v[28:31]
    s_waitcnt vmcnt(13)
    v_mfma_f32_16x16x32_bf16 v[16:19], a[80:83], a[4:7], v[16:19]
    v_mfma_f32_16x16x32_bf16 v[20:23], a[84:87], a[4:7], v[20:23]
    v_mfma_f32_16x16x32_bf16 v[24:27], a[88:91], a[4:7], v[24:27]
    v_mfma_f32_16x16x32_bf16 v[28:31], a[92:95], a[4:7], v[28:31]
    s_waitcnt vmcnt(12)
    v_mfma_f32_16x16x32_bf16 v[16:19], a[96:99], a[8:11], v[16:19]
    v_mfma_f32_16x16x32_bf16 v[20:23], a[100:103], a[8:11], v[20:23]
    v_mfma_f32_16x16x32_bf16 v[24:27], a[104:107], a[8:11], v[24:27]
    v_mfma_f32_16x16x32_bf16 v[28:31], a[108:111], a[8:11], v[28:31]
    s_waitcnt vmcnt(11)
    v_mfma_f32_16x16x32_bf16 v[16:19], a[112:115], a[12:15], v[16:19]
    v_mfma_f32_16x16x32_bf16 v[20:23], a[116:119], a[12:15], v[20:23]
    v_mfma_f32_16x16x32_bf16 v[24:27], a[120:123], a[12:15], v[24:27]
    v_mfma_f32_16x16x32_bf16 v[28:31], a[124:127], a[12:15], v[28:31]
    s_waitcnt vmcnt(10)
    v_mfma_f32_16x16x32_bf16 v[16:19], v[48:51], a[16:19], v[16:19]
    s_barrier
    v_mfma_f32_16x16x32_bf16 v[20:23], v[52:55], a[16:19], v[20:23]
    v_mfma_f32_16x16x32_bf16 v[24:27], v[56:59], a[16:19], v[24:27]
    v_mfma_f32_16x16x32_bf16 v[28:31], v[60:63], a[16:19], v[28:31]
    s_waitcnt vmcnt(9)
    v_mfma_f32_16x16x32_bf16 v[16:19], v[32:35], a[20:23], v[16:19]
    v_mfma_f32_16x16x32_bf16 v[20:23], v[36:39], a[20:23], v[20:23]
    s_waitcnt vmcnt(7)
    s_cmp_eq_u32 s86, 1
    s_cbranch_scc1 L_sw4
    v_swap_b32 v76, v82
    v_swap_b32 v77, v83
    s_branch L_sx4
L_sw4:
    v_swap_b32 v78, v80
    v_swap_b32 v79, v81
L_sx4:
    v_mfma_f32_16x16x32_bf16 v[24:27], v[40:43], a[20:23], v[24:27]
    v_mfma_f32_16x16x32_bf16 v[28:31], v[44:47], a[20:23], v[28:31]
    v_mfma_f32_16x16x32_bf16 v[16:19], a[48:51], v[76:79], v[16:19]
    v_mfma_f32_16x16x32_bf16 v[20:23], a[52:55], v[76:79], v[20:23]
    v_mfma_f32_16x16x32_bf16 v[24:27], a[56:59], v[76:79], v[24:27]
    v_mfma_f32_16x16x32_bf16 v[28:31], a[60:63], v[76:79], v[28:31]
    s_nop 4
    ds_write_b128 v98, v[16:19] offset:0
    ds_write_b128 v98, v[20:23] offset:1024
    ds_write_b128 v98, v[24:27] offset:2048
    ds_write_b128 v98, v[28:31] offset:3072
    s_waitcnt lgkmcnt(0)
    s_barrier
    ds_read_b128 v[16:19], v99 offset:0
    ds_read_b128 v[20:23], v99 offset:1024
    ds_read_b128 v[24:27], v99 offset:2048
    ds_read_b128 v[28:31], v99 offset:3072
    s_waitcnt lgkmcnt(0)
    s_waitcnt vmcnt(6)
    v_mfma_f32_16x16x32_bf16 v[16:19], a[64:67], a[24:27], v[16:19]
    v_mfma_f32_16x16x32_bf16 v[20:23], a[68:71], a[24:27], v[20:23]
    v_mfma_f32_16x16x32_bf16 v[24:27], a[72:75], a[24:27], v[24:27]
    v_mfma_f32_16x16x32_bf16 v[28:31], a[76:79], a[24:27], v[28:31]
    s_waitcnt vmcnt(5)
    v_mfma_f32_16x16x32_bf16 v[16:19], a[80:83], a[28:31], v[16:19]
    v_mfma_f32_16x16x32_bf16 v[20:23], a[84:87], a[28:31], v[20:23]
    v_mfma_f32_16x16x32_bf16 v[24:27], a[88:91], a[28:31], v[24:27]
    v_mfma_f32_16x16x32_bf16 v[28:31], a[92:95], a[28:31], v[28:31]
    s_waitcnt vmcnt(4)
    v_mfma_f32_16x16x32_bf16 v[16:19], a[96:99], a[32:35], v[16:19]
    v_mfma_f32_16x16x32_bf16 v[20:23], a[100:103], a[32:35], v[20:23]
    v_mfma_f32_16x16x32_bf16 v[24:27], a[104:107], a[32:35], v[24:27]
    v_mfma_f32_16x16x32_bf16 v[28:31], a[108:111], a[32:35], v[28:31]
    s_waitcnt vmcnt(3)
    v_mfma_f32_16x16x32_bf16 v[16:19], a[112:115], a[36:39], v[16:19]
    v_mfma_f32_16x16x32_bf16 v[20:23], a[116:119], a[36:39], v[20:23]
    v_mfma_f32_16x16x32_bf16 v[24:27], a[120:123], a[36:39], v[24:27]
    v_mfma_f32_16x16x32_bf16 v[28:31], a[124:127], a[36:39], v[28:31]
    s_waitcnt vmcnt(2)
    v_mfma_f32_16x16x32_bf16 v[16:19], v[48:51], a[40:43], v[16:19]
    v_mfma_f32_16x16x32_bf16 v[20:23], v[52:55], a[40:43], v[20:23]
    v_mfma_f32_16x16x32_bf16 v[24:27], v[56:59], a[40:43], v[24:27]
    v_mfma_f32_16x16x32_bf16 v[28:31], v[60:63], a[40:43], v[28:31]
    s_waitcnt vmcnt(1)
    v_mfma_f32_16x16x32_bf16 v[16:19], v[32:35], a[44:47], v[16:19]
    v_mfma_f32_16x16x32_bf16 v[20:23], v[36:39], a[44:47], v[20:23]
    v_mfma_f32_16x16x32_bf16 v[24:27], v[40:43], a[44:47], v[24:27]
    v_mfma_f32_16x16x32_bf16 v[28:31], v[44:47], a[44:47], v[28:31]
    v_mfma_f32_16x16x32_bf16 v[16:19], a[48:51], v[80:83], v[16:19]
    v_mfma_f32_16x16x32_bf16 v[20:23], a[52:55], v[80:83], v[20:23]
    v_mfma_f32_16x16x32_bf16 v[24:27], a[56:59], v[80:83], v[24:27]
    v_mfma_f32_16x16x32_bf16 v[28:31], a[60:63], v[80:83], v[28:31]
    s_nop 4
    ds_write_b128 v100, v[16:19] offset:0
    ds_write_b128 v100, v[20:23] offset:1024
    ds_read_b128 v[64:67], v110
    s_waitcnt lgkmcnt(0)
    v_lshlrev_b32 v32, 16, v64
    v_and_b32 v33, 0xffff0000, v64
    v_lshlrev_b32 v34, 16, v65
    v_and_b32 v35, 0xffff0000, v65
    v_lshlrev_b32 v36, 16, v66
    v_and_b32 v37, 0xffff0000, v66
    v_lshlrev_b32 v38, 16, v67
    v_and_b32 v39, 0xffff0000, v67
    s_waitcnt vmcnt(0)
    s_barrier
    ds_read_b64_tr_b16 v[44:45], v102 offset:0
    ds_read_b64_tr_b16 v[46:47], v102 offset:512
    ds_read_b128 v[16:19], v101 offset:0
    ds_read_b128 v[20:23], v101 offset:1024
    s_waitcnt lgkmcnt(2)
    v_lshlrev_b32 v40, 16, v44
    v_and_b32 v41, 0xffff0000, v44
    v_pk_add_f32 v[32:33], v[32:33], v[40:41]
    v_lshlrev_b32 v42, 16, v45
    v_and_b32 v43, 0xffff0000, v45
    v_pk_add_f32 v[34:35], v[34:35], v[42:43]
    v_lshlrev_b32 v40, 16, v46
    v_and_b32 v41, 0xffff0000, v46
    v_pk_add_f32 v[36:37], v[36:37], v[40:41]
    v_lshlrev_b32 v42, 16, v47
    v_and_b32 v43, 0xffff0000, v47
    v_pk_add_f32 v[38:39], v[38:39], v[42:43]
    s_waitcnt lgkmcnt(0)
    v_pk_add_f32 v[24:25], v[24:25], v[16:17]
    v_pk_add_f32 v[26:27], v[26:27], v[18:19]
    v_pk_add_f32 v[28:29], v[28:29], v[20:21]
    v_pk_add_f32 v[30:31], v[30:31], v[22:23]
    v_pk_fma_f32 v[24:25], v[24:25], v[14:15], v[32:33] op_sel:[0,0,0] op_sel_hi:[1,0,1]
    v_pk_fma_f32 v[26:27], v[26:27], v[14:15], v[34:35] op_sel:[0,0,0] op_sel_hi:[1,0,1]
    v_pk_fma_f32 v[28:29], v[28:29], v[14:15], v[36:37] op_sel:[0,0,0] op_sel_hi:[1,0,1]
    v_pk_fma_f32 v[30:31], v[30:31], v[14:15], v[38:39] op_sel:[0,0,0] op_sel_hi:[1,0,1]
    v_cvt_pk_bf16_f32 v64, v24, v25
    v_cvt_pk_bf16_f32 v65, v26, v27
    v_cvt_pk_bf16_f32 v66, v28, v29
    v_cvt_pk_bf16_f32 v67, v30, v31
    buffer_store_dwordx4 v[64:67], v103, s[24:27], 0 offen
    s_endpgm
L_end:
    s_endpgm
.section .rodata,"a"
.p2align 6
.amdhsa_kernel parallel_sum__ssm_conv_s4__dense_activation_relu__prompt_kernel
  .amdhsa_next_free_vgpr 256
  .amdhsa_next_free_sgpr 102
  .amdhsa_accum_offset 128
  .amdhsa_group_segment_fixed_size 0
  .amdhsa_kernarg_size 120
  .amdhsa_user_sgpr_count 2
  .amdhsa_user_sgpr_kernarg_segment_ptr 1
  .amdhsa_system_sgpr_workgroup_id_x 1
.end_amdhsa_kernel
```
